```python
import torch

def _softmax(x, axis=-1):
    return torch.softmax(x, dim=axis)
def _gelu(x):
    return torch.nn.functional.gelu(x, approximate="tanh")
def _silu(x):
    return torch.nn.functional.silu(x)
def _sigmoid(x):
    return torch.sigmoid(x)
def _layernorm(x, axis=-1, eps=1e-5):
    m = x.mean(dim=axis, keepdim=True)
    v = x.var(dim=axis, keepdim=True, unbiased=False)
    return (x - m) / torch.sqrt(v + eps)
def _scatter_add(tgt, idx, src, axis=0):
    return tgt.clone().index_add_(axis, idx, src)
def _segment_sum(src, seg, n):
    out = torch.zeros((n,) + src.shape[1:], dtype=src.dtype)
    return out.index_add_(0, seg, src)
def _pad(x, pw):
    flat = tuple(v for pair in reversed(pw) for v in pair)
    return torch.nn.functional.pad(x, flat)

kernel_name = 'recurrent_scan__grouped_kv_mqa__moe_arch_mod__prompt'

def setup_inputs():

    _w = (lambda a: (lambda t: t.to(torch.bfloat16) if t.is_floating_point() else t)(torch.as_tensor(a)))
    def _A_setup():
        B, S, D, H = 1, 2048, 640, 32
        Dh = D // H
        return {
            "x": _w((lambda *s: torch.randn(*s, dtype=torch.bfloat16) * 0.05)(B, S, D)),
            "wq": _w((lambda *s: torch.randn(*s, dtype=torch.bfloat16) * 0.05)(D, H * Dh)),
            "wk": _w((lambda *s: torch.randn(*s, dtype=torch.bfloat16) * 0.05)(D, Dh)),
            "wv": _w((lambda *s: torch.randn(*s, dtype=torch.bfloat16) * 0.05)(D, Dh)),
            "wo": _w((lambda *s: torch.randn(*s, dtype=torch.bfloat16) * 0.05)(H * Dh, D)),
        }
    _A_in = _A_setup()

    def _B_setup():
        B, S, D, F, C = 1, 2048, 640, 1728, 1
        return {
            "x": _w((lambda *s: torch.randn(*s, dtype=torch.bfloat16) * 0.05)(B, S, D)),
            "w_r": _w((lambda *s: torch.randn(*s, dtype=torch.bfloat16) * 1.6)(D)),
            "w_gate": _w((lambda *s: torch.randn(*s, dtype=torch.bfloat16) * 0.1)(D, F)),
            "w_up": _w((lambda *s: torch.randn(*s, dtype=torch.bfloat16) * 0.1)(D, F)),
            "w_down": _w((lambda *s: torch.randn(*s, dtype=torch.bfloat16) * 0.1)(F, D)),
        }
    _B_in = _B_setup()

    return {
        "A_x": _A_in["x"],
        "A_wq": _A_in["wq"],
        "A_wk": _A_in["wk"],
        "A_wv": _A_in["wv"],
        "A_wo": _A_in["wo"],
        "B_x": _B_in["x"],
        "B_w_r": _B_in["w_r"],
        "B_w_gate": _B_in["w_gate"],
        "B_w_up": _B_in["w_up"],
        "B_w_down": _B_in["w_down"],
    }

def reference(A_x, A_wq, A_wk, A_wv, A_wo, B_x, B_w_r, B_w_gate, B_w_up, B_w_down):
    def _A_ref(x, wq, wk, wv, wo):
        B, S, D = x.shape
        H = 32
        Dh = D // H
        q = (lambda x, *d: x.permute(*d))((x @ wq).reshape(B, S, H, Dh), 0, 2, 1, 3)
        k = x @ wk
        v = x @ wv
        scores = torch.einsum("bhqd,bkd->bhqk", q, k) * (Dh ** -0.5)
        p = _softmax(scores, axis=-1)
        o = torch.einsum("bhqk,bkd->bhqd", p, v)
        return (lambda x, *d: x.permute(*d))(o, 0, 2, 1, 3).reshape(B, S, H * Dh) @ wo

    def _B_ref(x, w_r, w_gate, w_up, w_down):
        B, S, D = x.shape
        C = 1
        r = x @ w_r
        idx = torch.argsort(-r, axis=-1)[:, :C]
        idx_e = (lambda x, n, axis: torch.repeat_interleave(x, n, dim=axis))(idx.reshape(B, C, 1), D, axis=2)
        x_sel = (lambda x, i, axis: torch.take_along_dim(x, i, dim=axis))(x, idx_e, axis=1)
        g = _silu(x_sel @ w_gate)
        u = x_sel @ w_up
        y = (g * u) @ w_down
        r_sel = _sigmoid((lambda x, i, axis: torch.take_along_dim(x, i, dim=axis))(r, idx, axis=1))
        y = y * r_sel.reshape(B, C, 1)
        b_off = (torch.arange(B) * S).reshape(B, 1)
        flat_idx = (idx + b_off).reshape(B * C)
        zero = (x * 0.0).reshape(B * S, D)
        upd = _scatter_add(zero, flat_idx, y.reshape(B * C, D), axis=0)
        return x + upd.reshape(B, S, D)

    x = A_x
    xn = _layernorm(x, axis=-1)
    s = _A_ref(xn, A_wq, A_wk, A_wv, A_wo)
    g = _silu(_B_ref(xn, B_w_r, B_w_gate, B_w_up, B_w_down))
    return x + s * g
```

```asm
; @launch kernel=l1_kernel grid=(256,1,1) block=(256,1,1) lds=124928
; @launch kernel=l2_kernel grid=(256,1,1) block=(576,1,1) lds=163840
; @launch kernel=l3_kernel grid=(256,1,1) block=(256,1,1) lds=121856
.amdgcn_target "amdgcn-amd-amdhsa--gfx950"
.text
.globl l1_kernel
.p2align 8
.type l1_kernel,@function
l1_kernel:
    s_cmp_ge_u32 s2, 256
    s_cbranch_scc1 l1_kernel_end
    s_load_dwordx16 s[16:31], s[0:1], 0
    s_load_dwordx8 s[32:39], s[0:1], 64
    s_load_dwordx2 s[40:41], s[0:1], 96
    v_lshrrev_b32 v1, 6, v0
    v_and_b32 v0, 63, v0
    s_and_b32 s4, s2, 7
    v_readfirstlane_b32 s3, v1
    s_lshr_b32 s5, s2, 3
    s_lshl_b32 s4, s4, 2
    s_lshr_b32 s6, s5, 3
    s_add_u32 s4, s4, s6
    s_and_b32 s5, s5, 7
    s_getpc_b64 s[14:15]
l1_kernel_pc:
    s_add_u32 s14, s14, l2_kernel-l1_kernel_pc
    s_addc_u32 s15, s15, 0
    s_lshr_b32 s13, s2, 3
    s_lshl_b32 s13, s13, 10
    s_lshl_b32 s12, s3, 8
    s_add_u32 s13, s13, s12
    v_lshlrev_b32 v227, 2, v0
    v_add_u32 v227, s13, v227
    v_min_u32 v227, l3_kernel_end-l2_kernel, v227
    global_load_dword v227, v227, s[14:15]
    v_bfe_u32 v4, v0, 2, 2
    v_lshrrev_b32 v3, 4, v0
    v_and_b32 v5, 3, v0
    v_mul_u32_u24 v4, 5120, v4
    v_lshl_add_u32 v4, v3, 6, v4
    v_lshl_add_u32 v197, v5, 4, v4
    v_lshrrev_b32 v4, 2, v0
    v_mul_u32_u24 v6, 160, v4
    v_mad_u32_u24 v198, v5, 40, v6
    v_add_u32 v199, 61440, v198
    v_lshlrev_b32 v6, 5, v4
    v_lshl_add_u32 v6, v5, 3, v6
    v_add_u32 v200, 102400, v6
    v_add_u32 v4, 0, v0
    v_mul_u32_u24 v5, 6554, v4
    v_lshrrev_b32 v5, 16, v5
    v_mul_u32_u24 v6, 10, v5
    v_sub_u32 v6, v4, v6
    v_bfe_u32 v7, v5, 2, 2
    v_lshrrev_b32 v8, 4, v5
    v_and_b32 v9, 3, v5
    v_mad_u32_u24 v9, v7, 32, v9
    v_mad_u32_u24 v9, v8, 4, v9
    v_mul_u32_u24 v9, 1280, v9
    v_lshl_add_u32 v192, v6, 4, v9
    v_add_u32 v4, 64, v0
    v_mul_u32_u24 v5, 6554, v4
    v_lshrrev_b32 v5, 16, v5
    v_mul_u32_u24 v6, 10, v5
    v_sub_u32 v6, v4, v6
    v_bfe_u32 v7, v5, 2, 2
    v_lshrrev_b32 v8, 4, v5
    v_and_b32 v9, 3, v5
    v_mad_u32_u24 v9, v7, 32, v9
    v_mad_u32_u24 v9, v8, 4, v9
    v_mul_u32_u24 v9, 1280, v9
    v_lshl_add_u32 v193, v6, 4, v9
    v_add_u32 v4, 128, v0
    v_mul_u32_u24 v5, 6554, v4
    v_lshrrev_b32 v5, 16, v5
    v_mul_u32_u24 v6, 10, v5
    v_sub_u32 v6, v4, v6
    v_bfe_u32 v7, v5, 2, 2
    v_lshrrev_b32 v8, 4, v5
    v_and_b32 v9, 3, v5
    v_mad_u32_u24 v9, v7, 32, v9
    v_mad_u32_u24 v9, v8, 4, v9
    v_mul_u32_u24 v9, 1280, v9
    v_lshl_add_u32 v194, v6, 4, v9
    v_add_u32 v4, 192, v0
    v_mul_u32_u24 v5, 6554, v4
    v_lshrrev_b32 v5, 16, v5
    v_mul_u32_u24 v6, 10, v5
    v_sub_u32 v6, v4, v6
    v_bfe_u32 v7, v5, 2, 2
    v_lshrrev_b32 v8, 4, v5
    v_and_b32 v9, 3, v5
    v_mad_u32_u24 v9, v7, 32, v9
    v_mad_u32_u24 v9, v8, 4, v9
    v_mul_u32_u24 v9, 1280, v9
    v_lshl_add_u32 v195, v6, 4, v9
    v_add_u32 v4, 256, v0
    v_mul_u32_u24 v5, 6554, v4
    v_lshrrev_b32 v5, 16, v5
    v_mul_u32_u24 v6, 10, v5
    v_sub_u32 v6, v4, v6
    v_bfe_u32 v7, v5, 2, 2
    v_lshrrev_b32 v8, 4, v5
    v_and_b32 v9, 3, v5
    v_mad_u32_u24 v9, v7, 32, v9
    v_mad_u32_u24 v9, v8, 4, v9
    v_mul_u32_u24 v9, 1280, v9
    v_lshl_add_u32 v196, v6, 4, v9
    s_lshl_b32 s7, s4, 6
    s_lshl_b32 s8, s3, 4
    s_add_u32 s7, s7, s8
    s_mul_i32 s6, s7, 1280
    s_mul_i32 s8, s3, 10240
    s_mul_i32 s9, s5, 160
    s_add_u32 s8, s8, s9
    s_mul_i32 s11, s3, 5120
    s_add_u32 s64, s4, s5
    s_mul_i32 s10, s64, 52
    s_lshr_b32 s10, s10, 8
    s_mul_i32 s10, s10, 5
    s_sub_u32 s64, s64, s10
    s_add_u32 s65, s64, 1
    s_cmp_eq_u32 s65, 5
    s_cselect_b32 s65, 0, s65
    s_add_u32 s66, s65, 1
    s_cmp_eq_u32 s66, 5
    s_cselect_b32 s66, 0, s66
    s_add_u32 s67, s66, 1
    s_cmp_eq_u32 s67, 5
    s_cselect_b32 s67, 0, s67
    s_add_u32 s68, s67, 1
    s_cmp_eq_u32 s68, 5
    s_cselect_b32 s68, 0, s68
    s_waitcnt lgkmcnt(0)
    s_mov_b32 s44, s16
    s_and_b32 s45, s17, 0xffff
    s_mov_b32 s46, 2621440
    s_mov_b32 s47, 0x00020000
    s_mov_b32 s48, s18
    s_and_b32 s49, s19, 0xffff
    s_mov_b32 s50, 819200
    s_mov_b32 s51, 0x00020000
    s_mov_b32 s52, s40
    s_and_b32 s53, s41, 0xffff
    s_mov_b32 s54, 9437184
    s_mov_b32 s55, 0x00020000
    v_lshl_add_u32 v4, v1, 6, v0
    v_lshrrev_b32 v5, 1, v4
    v_bfe_u32 v7, v5, 2, 2
    v_bfe_u32 v8, v5, 4, 1
    v_and_b32 v9, 3, v5
    v_lshl_add_u32 v9, v7, 5, v9
    v_lshl_add_u32 v9, v8, 2, v9
    v_lshrrev_b32 v5, 5, v5
    v_lshl_add_u32 v5, v5, 3, v9
    v_lshlrev_b32 v10, 4, v4
    v_add_u32 v10, 102400, v10
    s_cmp_ge_u32 s5, 4
    s_cbranch_scc1 l1_kernel_no6
    s_cmp_eq_u32 s5, 3
    s_cbranch_scc1 l1_kernel_r6
    s_cmp_eq_u32 s5, 2
    s_cselect_b32 s56, s22, s20
    s_cselect_b32 s57, s23, s21
    s_cmp_eq_u32 s5, 0
    s_cselect_b32 s60, s20, s22
    s_cselect_b32 s61, s21, s23
    s_and_b32 s57, s57, 0xffff
    s_and_b32 s61, s61, 0xffff
    s_mov_b32 s58, 25600
    s_mov_b32 s62, 25600
    s_mov_b32 s59, 0x00020000
    s_mov_b32 s63, 0x00020000
    s_cmp_eq_u32 s5, 1
    s_cselect_b32 s9, 24, 0
    s_cselect_b32 s10, 24, 16
    v_mul_u32_u24 v5, 40, v5
    s_mov_b32 exec_lo, 0x55555555
    s_mov_b32 exec_hi, 0x55555555
    s_mul_i32 s12, s64, 5120
    s_add_u32 s12, s12, s9
    buffer_load_dwordx4 v[144:147], v5, s[56:59], s12 offen
    s_mul_i32 s12, s65, 5120
    s_add_u32 s12, s12, s9
    buffer_load_dwordx4 v[148:151], v5, s[56:59], s12 offen
    s_mul_i32 s12, s66, 5120
    s_add_u32 s12, s12, s9
    buffer_load_dwordx4 v[152:155], v5, s[56:59], s12 offen
    s_mul_i32 s12, s67, 5120
    s_add_u32 s12, s12, s9
    buffer_load_dwordx4 v[156:159], v5, s[56:59], s12 offen
    s_mul_i32 s12, s68, 5120
    s_add_u32 s12, s12, s9
    buffer_load_dwordx4 v[160:163], v5, s[56:59], s12 offen
    s_mov_b32 exec_lo, 0xaaaaaaaa
    s_mov_b32 exec_hi, 0xaaaaaaaa
    s_mul_i32 s12, s64, 5120
    s_add_u32 s12, s12, s10
    buffer_load_dwordx4 v[144:147], v5, s[60:63], s12 offen
    s_mul_i32 s12, s65, 5120
    s_add_u32 s12, s12, s10
    buffer_load_dwordx4 v[148:151], v5, s[60:63], s12 offen
    s_mul_i32 s12, s66, 5120
    s_add_u32 s12, s12, s10
    buffer_load_dwordx4 v[152:155], v5, s[60:63], s12 offen
    s_mul_i32 s12, s67, 5120
    s_add_u32 s12, s12, s10
    buffer_load_dwordx4 v[156:159], v5, s[60:63], s12 offen
    s_mul_i32 s12, s68, 5120
    s_add_u32 s12, s12, s10
    buffer_load_dwordx4 v[160:163], v5, s[60:63], s12 offen
    s_mov_b64 exec, -1
    s_branch l1_kernel_no6
l1_kernel_r6:
    s_mov_b32 s56, s28
    s_and_b32 s57, s29, 0xffff
    s_mov_b32 s58, 1280
    s_mov_b32 s59, 0x00020000
    v_mov_b32 v144, 0
    v_mov_b32 v145, 0
    v_mov_b32 v146, 0
    v_mov_b32 v147, 0
    v_mov_b32 v148, 0
    v_mov_b32 v149, 0
    v_mov_b32 v150, 0
    v_mov_b32 v151, 0
    v_mov_b32 v152, 0
    v_mov_b32 v153, 0
    v_mov_b32 v154, 0
    v_mov_b32 v155, 0
    v_mov_b32 v156, 0
    v_mov_b32 v157, 0
    v_mov_b32 v158, 0
    v_mov_b32 v159, 0
    v_mov_b32 v160, 0
    v_mov_b32 v161, 0
    v_mov_b32 v162, 0
    v_mov_b32 v163, 0
    v_lshlrev_b32 v5, 1, v5
    s_mov_b32 exec_lo, 0x55555555
    s_mov_b32 exec_hi, 0x55555555
    s_lshl_b32 s12, s64, 8
    buffer_load_ushort v144, v5, s[56:59], s12 offen
    s_lshl_b32 s12, s65, 8
    buffer_load_ushort v148, v5, s[56:59], s12 offen
    s_lshl_b32 s12, s66, 8
    buffer_load_ushort v152, v5, s[56:59], s12 offen
    s_lshl_b32 s12, s67, 8
    buffer_load_ushort v156, v5, s[56:59], s12 offen
    s_lshl_b32 s12, s68, 8
    buffer_load_ushort v160, v5, s[56:59], s12 offen
    s_mov_b64 exec, -1
l1_kernel_no6:
    s_lshl_b32 s12, s64, 8
    s_mul_i32 s13, s64, 163840
    s_add_u32 s12, s12, s6
    s_add_u32 s13, s13, s8
    buffer_load_dwordx4 v[16:19], v197, s[44:47], s12 offen offset:0
    buffer_load_dwordx4 v[20:23], v197, s[44:47], s12 offen offset:1280
    buffer_load_dwordx4 v[24:27], v197, s[44:47], s12 offen offset:2560
    buffer_load_dwordx4 v[28:31], v197, s[44:47], s12 offen offset:3840
    s_add_u32 m0, s11, 0
    s_nop 0
    buffer_load_dwordx4 v192, s[48:51], s13 offen lds
    s_add_u32 m0, s11, 1024
    s_nop 0
    buffer_load_dwordx4 v193, s[48:51], s13 offen lds
    s_add_u32 m0, s11, 2048
    s_nop 0
    buffer_load_dwordx4 v194, s[48:51], s13 offen lds
    s_add_u32 m0, s11, 3072
    s_nop 0
    buffer_load_dwordx4 v195, s[48:51], s13 offen lds
    s_add_u32 m0, s11, 4096
    s_nop 0
    buffer_load_dwordx4 v196, s[48:51], s13 offen lds
    s_lshl_b32 s12, s65, 8
    s_mul_i32 s13, s65, 163840
    s_add_u32 s12, s12, s6
    s_add_u32 s13, s13, s8
    buffer_load_dwordx4 v[32:35], v197, s[44:47], s12 offen offset:0
    buffer_load_dwordx4 v[36:39], v197, s[44:47], s12 offen offset:1280
    buffer_load_dwordx4 v[40:43], v197, s[44:47], s12 offen offset:2560
    buffer_load_dwordx4 v[44:47], v197, s[44:47], s12 offen offset:3840
    s_add_u32 m0, s11, 20480
    s_nop 0
    buffer_load_dwordx4 v192, s[48:51], s13 offen lds
    s_add_u32 m0, s11, 21504
    s_nop 0
    buffer_load_dwordx4 v193, s[48:51], s13 offen lds
    s_add_u32 m0, s11, 22528
    s_nop 0
    buffer_load_dwordx4 v194, s[48:51], s13 offen lds
    s_add_u32 m0, s11, 23552
    s_nop 0
    buffer_load_dwordx4 v195, s[48:51], s13 offen lds
    s_add_u32 m0, s11, 24576
    s_nop 0
    buffer_load_dwordx4 v196, s[48:51], s13 offen lds
    v_mov_b32 v204, 0x3f803f80
    v_mov_b32 v205, 0x3f803f80
    v_mov_b32 v206, 0x3f803f80
    v_mov_b32 v207, 0x3f803f80
    s_cmp_ge_u32 s5, 4
    s_cbranch_scc1 l1_kernel_no6w
    s_waitcnt vmcnt(18)
    ds_write_b128 v10, v[144:147] offset:0
    ds_write_b128 v10, v[148:151] offset:4096
    ds_write_b128 v10, v[152:155] offset:8192
    ds_write_b128 v10, v[156:159] offset:12288
    ds_write_b128 v10, v[160:163] offset:16384
    s_waitcnt lgkmcnt(0)
l1_kernel_no6w:
    s_waitcnt vmcnt(14)
    s_mov_b32 vcc_lo, 0x55555555
    s_mov_b32 vcc_hi, 0x55555555
    v_cndmask_b32_dpp v212, v20, v16, vcc quad_perm:[1,0,3,2] row_mask:0xf bank_mask:0xf
    v_cndmask_b32_dpp v220, v28, v24, vcc quad_perm:[1,0,3,2] row_mask:0xf bank_mask:0xf
    v_cndmask_b32_dpp v213, v21, v17, vcc quad_perm:[1,0,3,2] row_mask:0xf bank_mask:0xf
    v_cndmask_b32_dpp v221, v29, v25, vcc quad_perm:[1,0,3,2] row_mask:0xf bank_mask:0xf
    v_cndmask_b32_dpp v214, v22, v18, vcc quad_perm:[1,0,3,2] row_mask:0xf bank_mask:0xf
    v_cndmask_b32_dpp v222, v30, v26, vcc quad_perm:[1,0,3,2] row_mask:0xf bank_mask:0xf
    v_cndmask_b32_dpp v215, v23, v19, vcc quad_perm:[1,0,3,2] row_mask:0xf bank_mask:0xf
    v_cndmask_b32_dpp v223, v31, v27, vcc quad_perm:[1,0,3,2] row_mask:0xf bank_mask:0xf
    s_mov_b32 vcc_lo, 0xaaaaaaaa
    s_mov_b32 vcc_hi, 0xaaaaaaaa
    v_cndmask_b32_dpp v216, v16, v20, vcc quad_perm:[1,0,3,2] row_mask:0xf bank_mask:0xf
    v_cndmask_b32_dpp v224, v24, v28, vcc quad_perm:[1,0,3,2] row_mask:0xf bank_mask:0xf
    v_cndmask_b32_dpp v217, v17, v21, vcc quad_perm:[1,0,3,2] row_mask:0xf bank_mask:0xf
    v_cndmask_b32_dpp v225, v25, v29, vcc quad_perm:[1,0,3,2] row_mask:0xf bank_mask:0xf
    v_cndmask_b32_dpp v218, v18, v22, vcc quad_perm:[1,0,3,2] row_mask:0xf bank_mask:0xf
    v_cndmask_b32_dpp v226, v26, v30, vcc quad_perm:[1,0,3,2] row_mask:0xf bank_mask:0xf
    v_cndmask_b32_dpp v219, v19, v23, vcc quad_perm:[1,0,3,2] row_mask:0xf bank_mask:0xf
    v_cndmask_b32_dpp v227, v27, v31, vcc quad_perm:[1,0,3,2] row_mask:0xf bank_mask:0xf
    s_mov_b32 vcc_lo, 0x33333333
    s_mov_b32 vcc_hi, 0x33333333
    v_cndmask_b32_dpp v16, v220, v212, vcc quad_perm:[2,3,0,1] row_mask:0xf bank_mask:0xf
    v_cndmask_b32_dpp v20, v224, v216, vcc quad_perm:[2,3,0,1] row_mask:0xf bank_mask:0xf
    v_cndmask_b32_dpp v17, v221, v213, vcc quad_perm:[2,3,0,1] row_mask:0xf bank_mask:0xf
    v_cndmask_b32_dpp v21, v225, v217, vcc quad_perm:[2,3,0,1] row_mask:0xf bank_mask:0xf
    v_cndmask_b32_dpp v18, v222, v214, vcc quad_perm:[2,3,0,1] row_mask:0xf bank_mask:0xf
    v_cndmask_b32_dpp v22, v226, v218, vcc quad_perm:[2,3,0,1] row_mask:0xf bank_mask:0xf
    v_cndmask_b32_dpp v19, v223, v215, vcc quad_perm:[2,3,0,1] row_mask:0xf bank_mask:0xf
    v_cndmask_b32_dpp v23, v227, v219, vcc quad_perm:[2,3,0,1] row_mask:0xf bank_mask:0xf
    s_mov_b32 vcc_lo, 0xcccccccc
    s_mov_b32 vcc_hi, 0xcccccccc
    v_cndmask_b32_dpp v24, v212, v220, vcc quad_perm:[2,3,0,1] row_mask:0xf bank_mask:0xf
    v_cndmask_b32_dpp v28, v216, v224, vcc quad_perm:[2,3,0,1] row_mask:0xf bank_mask:0xf
    v_cndmask_b32_dpp v25, v213, v221, vcc quad_perm:[2,3,0,1] row_mask:0xf bank_mask:0xf
    v_cndmask_b32_dpp v29, v217, v225, vcc quad_perm:[2,3,0,1] row_mask:0xf bank_mask:0xf
    v_cndmask_b32_dpp v26, v214, v222, vcc quad_perm:[2,3,0,1] row_mask:0xf bank_mask:0xf
    v_cndmask_b32_dpp v30, v218, v226, vcc quad_perm:[2,3,0,1] row_mask:0xf bank_mask:0xf
    v_cndmask_b32_dpp v27, v215, v223, vcc quad_perm:[2,3,0,1] row_mask:0xf bank_mask:0xf
    v_cndmask_b32_dpp v31, v219, v227, vcc quad_perm:[2,3,0,1] row_mask:0xf bank_mask:0xf
    s_waitcnt vmcnt(9)
    s_barrier
    s_lshl_b32 s12, s66, 8
    s_mul_i32 s13, s66, 163840
    s_add_u32 s12, s12, s6
    s_add_u32 s13, s13, s8
    ds_read_b64_tr_b16 v[144:145], v198 offset:0
    ds_read_b64_tr_b16 v[146:147], v198 offset:2560
    ds_read_b64_tr_b16 v[148:149], v198 offset:8
    ds_read_b64_tr_b16 v[150:151], v198 offset:2568
    ds_read_b64_tr_b16 v[152:153], v198 offset:16
    ds_read_b64_tr_b16 v[154:155], v198 offset:2576
    ds_read_b64_tr_b16 v[156:157], v198 offset:24
    ds_read_b64_tr_b16 v[158:159], v198 offset:2584
    ds_read_b64_tr_b16 v[160:161], v198 offset:32
    ds_read_b64_tr_b16 v[162:163], v198 offset:2592
    ds_read_b64_tr_b16 v[164:165], v200 offset:0
    ds_read_b64_tr_b16 v[166:167], v200 offset:512
    ds_read_b64_tr_b16 v[168:169], v198 offset:5120
    ds_read_b64_tr_b16 v[170:171], v198 offset:7680
    s_waitcnt lgkmcnt(12)
    v_mfma_f32_16x16x32_bf16 v[96:99], v[144:147], v[16:19], 0
    buffer_load_dwordx4 v[48:51], v197, s[44:47], s12 offen offset:0
    ds_read_b64_tr_b16 v[172:173], v198 offset:5128
    ds_read_b64_tr_b16 v[174:175], v198 offset:7688
    s_waitcnt lgkmcnt(12)
    v_mfma_f32_16x16x32_bf16 v[100:103], v[148:151], v[16:19], 0
    v_mfma_f32_16x16x32_bf16 v[208:211], v[204:207], v[16:19], 0
    ds_read_b64_tr_b16 v[176:177], v198 offset:5136
    ds_read_b64_tr_b16 v[178:179], v198 offset:7696
    s_waitcnt lgkmcnt(12)
    v_mfma_f32_16x16x32_bf16 v[104:107], v[152:155], v[16:19], 0
    buffer_load_dwordx4 v[52:55], v197, s[44:47], s12 offen offset:1280
    ds_read_b64_tr_b16 v[180:181], v198 offset:5144
    ds_read_b64_tr_b16 v[182:183], v198 offset:7704
    s_waitcnt lgkmcnt(12)
    v_mfma_f32_16x16x32_bf16 v[108:111], v[156:159], v[16:19], 0
    v_mfma_f32_16x16x32_bf16 v[228:231], v[16:19], v[16:19], 0
    ds_read_b64_tr_b16 v[184:185], v198 offset:5152
    ds_read_b64_tr_b16 v[186:187], v198 offset:7712
    s_waitcnt lgkmcnt(12)
    v_mfma_f32_16x16x32_bf16 v[112:115], v[160:163], v[16:19], 0
    buffer_load_dwordx4 v[56:59], v197, s[44:47], s12 offen offset:2560
    ds_read_b64_tr_b16 v[188:189], v200 offset:1024
    ds_read_b64_tr_b16 v[190:191], v200 offset:1536
    s_waitcnt lgkmcnt(12)
    v_mfma_f32_16x16x32_bf16 v[116:119], v[164:167], v[16:19], 0
    s_cmp_lg_u32 s3, 0
    s_cbranch_scc1 l1_kernel_cs0
    v_mfma_f32_16x16x32_bf16 v[120:123], v[144:147], v[204:207], 0
    v_mfma_f32_16x16x32_bf16 v[124:127], v[148:151], v[204:207], 0
    v_mfma_f32_16x16x32_bf16 v[128:131], v[152:155], v[204:207], 0
    v_mfma_f32_16x16x32_bf16 v[132:135], v[156:159], v[204:207], 0
    v_mfma_f32_16x16x32_bf16 v[136:139], v[160:163], v[204:207], 0
    v_mfma_f32_16x16x32_bf16 v[140:143], v[164:167], v[204:207], 0
l1_kernel_cs0:
    ds_read_b64_tr_b16 v[144:145], v198 offset:10240
    ds_read_b64_tr_b16 v[146:147], v198 offset:12800
    s_waitcnt lgkmcnt(12)
    v_mfma_f32_16x16x32_bf16 v[96:99], v[168:171], v[20:23], v[96:99]
    buffer_load_dwordx4 v[60:63], v197, s[44:47], s12 offen offset:3840
    ds_read_b64_tr_b16 v[148:149], v198 offset:10248
    ds_read_b64_tr_b16 v[150:151], v198 offset:12808
    s_waitcnt lgkmcnt(12)
    v_mfma_f32_16x16x32_bf16 v[100:103], v[172:175], v[20:23], v[100:103]
    v_mfma_f32_16x16x32_bf16 v[208:211], v[204:207], v[20:23], v[208:211]
    ds_read_b64_tr_b16 v[152:153], v198 offset:10256
    ds_read_b64_tr_b16 v[154:155], v198 offset:12816
    s_waitcnt lgkmcnt(12)
    v_mfma_f32_16x16x32_bf16 v[104:107], v[176:179], v[20:23], v[104:107]
    s_add_u32 m0, s11, 40960
    s_nop 0
    buffer_load_dwordx4 v192, s[48:51], s13 offen lds
    ds_read_b64_tr_b16 v[156:157], v198 offset:10264
    ds_read_b64_tr_b16 v[158:159], v198 offset:12824
    s_waitcnt lgkmcnt(12)
    v_mfma_f32_16x16x32_bf16 v[108:111], v[180:183], v[20:23], v[108:111]
    v_mfma_f32_16x16x32_bf16 v[228:231], v[20:23], v[20:23], v[228:231]
    ds_read_b64_tr_b16 v[160:161], v198 offset:10272
    ds_read_b64_tr_b16 v[162:163], v198 offset:12832
    s_waitcnt lgkmcnt(12)
    v_mfma_f32_16x16x32_bf16 v[112:115], v[184:187], v[20:23], v[112:115]
    s_add_u32 m0, s11, 41984
    s_nop 0
    buffer_load_dwordx4 v193, s[48:51], s13 offen lds
    ds_read_b64_tr_b16 v[164:165], v200 offset:2048
    ds_read_b64_tr_b16 v[166:167], v200 offset:2560
    s_waitcnt lgkmcnt(12)
    v_mfma_f32_16x16x32_bf16 v[116:119], v[188:191], v[20:23], v[116:119]
    s_cmp_lg_u32 s3, 1
    s_cbranch_scc1 l1_kernel_cs1
    v_mfma_f32_16x16x32_bf16 v[120:123], v[168:171], v[204:207], 0
    v_mfma_f32_16x16x32_bf16 v[124:127], v[172:175], v[204:207], 0
    v_mfma_f32_16x16x32_bf16 v[128:131], v[176:179], v[204:207], 0
    v_mfma_f32_16x16x32_bf16 v[132:135], v[180:183], v[204:207], 0
    v_mfma_f32_16x16x32_bf16 v[136:139], v[184:187], v[204:207], 0
    v_mfma_f32_16x16x32_bf16 v[140:143], v[188:191], v[204:207], 0
l1_kernel_cs1:
    s_waitcnt vmcnt(11)
    ds_read_b64_tr_b16 v[168:169], v198 offset:15360
    ds_read_b64_tr_b16 v[170:171], v198 offset:17920
    s_waitcnt lgkmcnt(12)
    v_mfma_f32_16x16x32_bf16 v[96:99], v[144:147], v[24:27], v[96:99]
    s_add_u32 m0, s11, 43008
    s_nop 0
    buffer_load_dwordx4 v194, s[48:51], s13 offen lds
    s_mov_b32 vcc_lo, 0x55555555
    s_mov_b32 vcc_hi, 0x55555555
    v_cndmask_b32_dpp v212, v36, v32, vcc quad_perm:[1,0,3,2] row_mask:0xf bank_mask:0xf
    v_cndmask_b32_dpp v220, v44, v40, vcc quad_perm:[1,0,3,2] row_mask:0xf bank_mask:0xf
    ds_read_b64_tr_b16 v[172:173], v198 offset:15368
    ds_read_b64_tr_b16 v[174:175], v198 offset:17928
    s_waitcnt lgkmcnt(12)
    v_mfma_f32_16x16x32_bf16 v[100:103], v[148:151], v[24:27], v[100:103]
    v_mfma_f32_16x16x32_bf16 v[208:211], v[204:207], v[24:27], v[208:211]
    v_cndmask_b32_dpp v213, v37, v33, vcc quad_perm:[1,0,3,2] row_mask:0xf bank_mask:0xf
    v_cndmask_b32_dpp v221, v45, v41, vcc quad_perm:[1,0,3,2] row_mask:0xf bank_mask:0xf
    v_cndmask_b32_dpp v214, v38, v34, vcc quad_perm:[1,0,3,2] row_mask:0xf bank_mask:0xf
    ds_read_b64_tr_b16 v[176:177], v198 offset:15376
    ds_read_b64_tr_b16 v[178:179], v198 offset:17936
    s_waitcnt lgkmcnt(12)
    v_mfma_f32_16x16x32_bf16 v[104:107], v[152:155], v[24:27], v[104:107]
    s_add_u32 m0, s11, 44032
    s_nop 0
    buffer_load_dwordx4 v195, s[48:51], s13 offen lds
    v_cndmask_b32_dpp v222, v46, v42, vcc quad_perm:[1,0,3,2] row_mask:0xf bank_mask:0xf
    v_cndmask_b32_dpp v215, v39, v35, vcc quad_perm:[1,0,3,2] row_mask:0xf bank_mask:0xf
    v_cndmask_b32_dpp v223, v47, v43, vcc quad_perm:[1,0,3,2] row_mask:0xf bank_mask:0xf
    ds_read_b64_tr_b16 v[180:181], v198 offset:15384
    ds_read_b64_tr_b16 v[182:183], v198 offset:17944
    s_waitcnt lgkmcnt(12)
    v_mfma_f32_16x16x32_bf16 v[108:111], v[156:159], v[24:27], v[108:111]
    v_mfma_f32_16x16x32_bf16 v[228:231], v[24:27], v[24:27], v[228:231]
    s_mov_b32 vcc_lo, 0xaaaaaaaa
    s_mov_b32 vcc_hi, 0xaaaaaaaa
    v_cndmask_b32_dpp v216, v32, v36, vcc quad_perm:[1,0,3,2] row_mask:0xf bank_mask:0xf
    v_cndmask_b32_dpp v224, v40, v44, vcc quad_perm:[1,0,3,2] row_mask:0xf bank_mask:0xf
    ds_read_b64_tr_b16 v[184:185], v198 offset:15392
    ds_read_b64_tr_b16 v[186:187], v198 offset:17952
    s_waitcnt lgkmcnt(12)
    v_mfma_f32_16x16x32_bf16 v[112:115], v[160:163], v[24:27], v[112:115]
    s_add_u32 m0, s11, 45056
    s_nop 0
    buffer_load_dwordx4 v196, s[48:51], s13 offen lds
    v_cndmask_b32_dpp v217, v33, v37, vcc quad_perm:[1,0,3,2] row_mask:0xf bank_mask:0xf
    v_cndmask_b32_dpp v225, v41, v45, vcc quad_perm:[1,0,3,2] row_mask:0xf bank_mask:0xf
    v_cndmask_b32_dpp v218, v34, v38, vcc quad_perm:[1,0,3,2] row_mask:0xf bank_mask:0xf
    ds_read_b64_tr_b16 v[188:189], v200 offset:3072
    ds_read_b64_tr_b16 v[190:191], v200 offset:3584
    s_waitcnt lgkmcnt(12)
    v_mfma_f32_16x16x32_bf16 v[116:119], v[164:167], v[24:27], v[116:119]
    v_cndmask_b32_dpp v226, v42, v46, vcc quad_perm:[1,0,3,2] row_mask:0xf bank_mask:0xf
    v_cndmask_b32_dpp v219, v35, v39, vcc quad_perm:[1,0,3,2] row_mask:0xf bank_mask:0xf
    v_cndmask_b32_dpp v227, v43, v47, vcc quad_perm:[1,0,3,2] row_mask:0xf bank_mask:0xf
    s_cmp_lg_u32 s3, 2
    s_cbranch_scc1 l1_kernel_cs2
    v_mfma_f32_16x16x32_bf16 v[120:123], v[144:147], v[204:207], 0
    v_mfma_f32_16x16x32_bf16 v[124:127], v[148:151], v[204:207], 0
    v_mfma_f32_16x16x32_bf16 v[128:131], v[152:155], v[204:207], 0
    v_mfma_f32_16x16x32_bf16 v[132:135], v[156:159], v[204:207], 0
    v_mfma_f32_16x16x32_bf16 v[136:139], v[160:163], v[204:207], 0
    v_mfma_f32_16x16x32_bf16 v[140:143], v[164:167], v[204:207], 0
l1_kernel_cs2:
    s_waitcnt vmcnt(9)
    s_barrier
    s_lshl_b32 s12, s67, 8
    s_mul_i32 s13, s67, 163840
    s_add_u32 s12, s12, s6
    s_add_u32 s13, s13, s8
    ds_read_b64_tr_b16 v[144:145], v198 offset:20480
    ds_read_b64_tr_b16 v[146:147], v198 offset:23040
    s_waitcnt lgkmcnt(12)
    v_mfma_f32_16x16x32_bf16 v[96:99], v[168:171], v[28:31], v[96:99]
    buffer_load_dwordx4 v[64:67], v197, s[44:47], s12 offen offset:0
    s_mov_b32 vcc_lo, 0x33333333
    s_mov_b32 vcc_hi, 0x33333333
    v_cndmask_b32_dpp v32, v220, v212, vcc quad_perm:[2,3,0,1] row_mask:0xf bank_mask:0xf
    v_cndmask_b32_dpp v36, v224, v216, vcc quad_perm:[2,3,0,1] row_mask:0xf bank_mask:0xf
    ds_read_b64_tr_b16 v[148:149], v198 offset:20488
    ds_read_b64_tr_b16 v[150:151], v198 offset:23048
    s_waitcnt lgkmcnt(12)
    v_mfma_f32_16x16x32_bf16 v[100:103], v[172:175], v[28:31], v[100:103]
    v_mfma_f32_16x16x32_bf16 v[208:211], v[204:207], v[28:31], v[208:211]
    v_cndmask_b32_dpp v33, v221, v213, vcc quad_perm:[2,3,0,1] row_mask:0xf bank_mask:0xf
    v_cndmask_b32_dpp v37, v225, v217, vcc quad_perm:[2,3,0,1] row_mask:0xf bank_mask:0xf
    v_cndmask_b32_dpp v34, v222, v214, vcc quad_perm:[2,3,0,1] row_mask:0xf bank_mask:0xf
    ds_read_b64_tr_b16 v[152:153], v198 offset:20496
    ds_read_b64_tr_b16 v[154:155], v198 offset:23056
    s_waitcnt lgkmcnt(12)
    v_mfma_f32_16x16x32_bf16 v[104:107], v[176:179], v[28:31], v[104:107]
    buffer_load_dwordx4 v[68:71], v197, s[44:47], s12 offen offset:1280
    v_cndmask_b32_dpp v38, v226, v218, vcc quad_perm:[2,3,0,1] row_mask:0xf bank_mask:0xf
    v_cndmask_b32_dpp v35, v223, v215, vcc quad_perm:[2,3,0,1] row_mask:0xf bank_mask:0xf
    v_cndmask_b32_dpp v39, v227, v219, vcc quad_perm:[2,3,0,1] row_mask:0xf bank_mask:0xf
    ds_read_b64_tr_b16 v[156:157], v198 offset:20504
    ds_read_b64_tr_b16 v[158:159], v198 offset:23064
    s_waitcnt lgkmcnt(12)
    v_mfma_f32_16x16x32_bf16 v[108:111], v[180:183], v[28:31], v[108:111]
    v_mfma_f32_16x16x32_bf16 v[228:231], v[28:31], v[28:31], v[228:231]
    s_mov_b32 vcc_lo, 0xcccccccc
    s_mov_b32 vcc_hi, 0xcccccccc
    v_cndmask_b32_dpp v40, v212, v220, vcc quad_perm:[2,3,0,1] row_mask:0xf bank_mask:0xf
    v_cndmask_b32_dpp v44, v216, v224, vcc quad_perm:[2,3,0,1] row_mask:0xf bank_mask:0xf
    ds_read_b64_tr_b16 v[160:161], v198 offset:20512
    ds_read_b64_tr_b16 v[162:163], v198 offset:23072
    s_waitcnt lgkmcnt(12)
    v_mfma_f32_16x16x32_bf16 v[112:115], v[184:187], v[28:31], v[112:115]
    buffer_load_dwordx4 v[72:75], v197, s[44:47], s12 offen offset:2560
    v_cndmask_b32_dpp v41, v213, v221, vcc quad_perm:[2,3,0,1] row_mask:0xf bank_mask:0xf
    v_cndmask_b32_dpp v45, v217, v225, vcc quad_perm:[2,3,0,1] row_mask:0xf bank_mask:0xf
    v_cndmask_b32_dpp v42, v214, v222, vcc quad_perm:[2,3,0,1] row_mask:0xf bank_mask:0xf
    ds_read_b64_tr_b16 v[164:165], v200 offset:4096
    ds_read_b64_tr_b16 v[166:167], v200 offset:4608
    s_waitcnt lgkmcnt(12)
    v_mfma_f32_16x16x32_bf16 v[116:119], v[188:191], v[28:31], v[116:119]
    v_cndmask_b32_dpp v46, v218, v226, vcc quad_perm:[2,3,0,1] row_mask:0xf bank_mask:0xf
    v_cndmask_b32_dpp v43, v215, v223, vcc quad_perm:[2,3,0,1] row_mask:0xf bank_mask:0xf
    v_cndmask_b32_dpp v47, v219, v227, vcc quad_perm:[2,3,0,1] row_mask:0xf bank_mask:0xf
    s_cmp_lg_u32 s3, 3
    s_cbranch_scc1 l1_kernel_cs3
    v_mfma_f32_16x16x32_bf16 v[120:123], v[168:171], v[204:207], 0
    v_mfma_f32_16x16x32_bf16 v[124:127], v[172:175], v[204:207], 0
    v_mfma_f32_16x16x32_bf16 v[128:131], v[176:179], v[204:207], 0
    v_mfma_f32_16x16x32_bf16 v[132:135], v[180:183], v[204:207], 0
    v_mfma_f32_16x16x32_bf16 v[136:139], v[184:187], v[204:207], 0
    v_mfma_f32_16x16x32_bf16 v[140:143], v[188:191], v[204:207], 0
l1_kernel_cs3:
    ds_read_b64_tr_b16 v[168:169], v198 offset:25600
    ds_read_b64_tr_b16 v[170:171], v198 offset:28160
    s_waitcnt lgkmcnt(12)
    v_mfma_f32_16x16x32_bf16 v[96:99], v[144:147], v[32:35], v[96:99]
    buffer_load_dwordx4 v[76:79], v197, s[44:47], s12 offen offset:3840
    ds_read_b64_tr_b16 v[172:173], v198 offset:25608
    ds_read_b64_tr_b16 v[174:175], v198 offset:28168
    s_waitcnt lgkmcnt(12)
    v_mfma_f32_16x16x32_bf16 v[100:103], v[148:151], v[32:35], v[100:103]
    v_mfma_f32_16x16x32_bf16 v[208:211], v[204:207], v[32:35], v[208:211]
    ds_read_b64_tr_b16 v[176:177], v198 offset:25616
    ds_read_b64_tr_b16 v[178:179], v198 offset:28176
    s_waitcnt lgkmcnt(12)
    v_mfma_f32_16x16x32_bf16 v[104:107], v[152:155], v[32:35], v[104:107]
    s_add_u32 m0, s11, 61440
    s_nop 0
    buffer_load_dwordx4 v192, s[48:51], s13 offen lds
    ds_read_b64_tr_b16 v[180:181], v198 offset:25624
    ds_read_b64_tr_b16 v[182:183], v198 offset:28184
    s_waitcnt lgkmcnt(12)
    v_mfma_f32_16x16x32_bf16 v[108:111], v[156:159], v[32:35], v[108:111]
    v_mfma_f32_16x16x32_bf16 v[228:231], v[32:35], v[32:35], v[228:231]
    ds_read_b64_tr_b16 v[184:185], v198 offset:25632
    ds_read_b64_tr_b16 v[186:187], v198 offset:28192
    s_waitcnt lgkmcnt(12)
    v_mfma_f32_16x16x32_bf16 v[112:115], v[160:163], v[32:35], v[112:115]
    s_add_u32 m0, s11, 62464
    s_nop 0
    buffer_load_dwordx4 v193, s[48:51], s13 offen lds
    ds_read_b64_tr_b16 v[188:189], v200 offset:5120
    ds_read_b64_tr_b16 v[190:191], v200 offset:5632
    s_waitcnt lgkmcnt(12)
    v_mfma_f32_16x16x32_bf16 v[116:119], v[164:167], v[32:35], v[116:119]
    s_cmp_lg_u32 s3, 0
    s_cbranch_scc1 l1_kernel_cs4
    v_mfma_f32_16x16x32_bf16 v[120:123], v[144:147], v[204:207], v[120:123]
    v_mfma_f32_16x16x32_bf16 v[124:127], v[148:151], v[204:207], v[124:127]
    v_mfma_f32_16x16x32_bf16 v[128:131], v[152:155], v[204:207], v[128:131]
    v_mfma_f32_16x16x32_bf16 v[132:135], v[156:159], v[204:207], v[132:135]
    v_mfma_f32_16x16x32_bf16 v[136:139], v[160:163], v[204:207], v[136:139]
    v_mfma_f32_16x16x32_bf16 v[140:143], v[164:167], v[204:207], v[140:143]
l1_kernel_cs4:
    ds_read_b64_tr_b16 v[144:145], v198 offset:30720
    ds_read_b64_tr_b16 v[146:147], v198 offset:33280
    s_waitcnt lgkmcnt(12)
    v_mfma_f32_16x16x32_bf16 v[96:99], v[168:171], v[36:39], v[96:99]
    s_add_u32 m0, s11, 63488
    s_nop 0
    buffer_load_dwordx4 v194, s[48:51], s13 offen lds
    ds_read_b64_tr_b16 v[148:149], v198 offset:30728
    ds_read_b64_tr_b16 v[150:151], v198 offset:33288
    s_waitcnt lgkmcnt(12)
    v_mfma_f32_16x16x32_bf16 v[100:103], v[172:175], v[36:39], v[100:103]
    v_mfma_f32_16x16x32_bf16 v[208:211], v[204:207], v[36:39], v[208:211]
    ds_read_b64_tr_b16 v[152:153], v198 offset:30736
    ds_read_b64_tr_b16 v[154:155], v198 offset:33296
    s_waitcnt lgkmcnt(12)
    v_mfma_f32_16x16x32_bf16 v[104:107], v[176:179], v[36:39], v[104:107]
    s_add_u32 m0, s11, 64512
    s_nop 0
    buffer_load_dwordx4 v195, s[48:51], s13 offen lds
    ds_read_b64_tr_b16 v[156:157], v198 offset:30744
    ds_read_b64_tr_b16 v[158:159], v198 offset:33304
    s_waitcnt lgkmcnt(12)
    v_mfma_f32_16x16x32_bf16 v[108:111], v[180:183], v[36:39], v[108:111]
    v_mfma_f32_16x16x32_bf16 v[228:231], v[36:39], v[36:39], v[228:231]
    ds_read_b64_tr_b16 v[160:161], v198 offset:30752
    ds_read_b64_tr_b16 v[162:163], v198 offset:33312
    s_waitcnt lgkmcnt(12)
    v_mfma_f32_16x16x32_bf16 v[112:115], v[184:187], v[36:39], v[112:115]
    s_add_u32 m0, s11, 65536
    s_nop 0
    buffer_load_dwordx4 v196, s[48:51], s13 offen lds
    ds_read_b64_tr_b16 v[164:165], v200 offset:6144
    ds_read_b64_tr_b16 v[166:167], v200 offset:6656
    s_waitcnt lgkmcnt(12)
    v_mfma_f32_16x16x32_bf16 v[116:119], v[188:191], v[36:39], v[116:119]
    s_cmp_lg_u32 s3, 1
    s_cbranch_scc1 l1_kernel_cs5
    v_mfma_f32_16x16x32_bf16 v[120:123], v[168:171], v[204:207], v[120:123]
    v_mfma_f32_16x16x32_bf16 v[124:127], v[172:175], v[204:207], v[124:127]
    v_mfma_f32_16x16x32_bf16 v[128:131], v[176:179], v[204:207], v[128:131]
    v_mfma_f32_16x16x32_bf16 v[132:135], v[180:183], v[204:207], v[132:135]
    v_mfma_f32_16x16x32_bf16 v[136:139], v[184:187], v[204:207], v[136:139]
    v_mfma_f32_16x16x32_bf16 v[140:143], v[188:191], v[204:207], v[140:143]
l1_kernel_cs5:
    s_waitcnt vmcnt(14)
    ds_read_b64_tr_b16 v[168:169], v198 offset:35840
    ds_read_b64_tr_b16 v[170:171], v198 offset:38400
    s_waitcnt lgkmcnt(12)
    v_mfma_f32_16x16x32_bf16 v[96:99], v[144:147], v[40:43], v[96:99]
    s_mov_b32 vcc_lo, 0x55555555
    s_mov_b32 vcc_hi, 0x55555555
    v_cndmask_b32_dpp v212, v52, v48, vcc quad_perm:[1,0,3,2] row_mask:0xf bank_mask:0xf
    v_cndmask_b32_dpp v220, v60, v56, vcc quad_perm:[1,0,3,2] row_mask:0xf bank_mask:0xf
    ds_read_b64_tr_b16 v[172:173], v198 offset:35848
    ds_read_b64_tr_b16 v[174:175], v198 offset:38408
    s_waitcnt lgkmcnt(12)
    v_mfma_f32_16x16x32_bf16 v[100:103], v[148:151], v[40:43], v[100:103]
    v_mfma_f32_16x16x32_bf16 v[208:211], v[204:207], v[40:43], v[208:211]
    v_cndmask_b32_dpp v213, v53, v49, vcc quad_perm:[1,0,3,2] row_mask:0xf bank_mask:0xf
    v_cndmask_b32_dpp v221, v61, v57, vcc quad_perm:[1,0,3,2] row_mask:0xf bank_mask:0xf
    v_cndmask_b32_dpp v214, v54, v50, vcc quad_perm:[1,0,3,2] row_mask:0xf bank_mask:0xf
    ds_read_b64_tr_b16 v[176:177], v198 offset:35856
    ds_read_b64_tr_b16 v[178:179], v198 offset:38416
    s_waitcnt lgkmcnt(12)
    v_mfma_f32_16x16x32_bf16 v[104:107], v[152:155], v[40:43], v[104:107]
    v_cndmask_b32_dpp v222, v62, v58, vcc quad_perm:[1,0,3,2] row_mask:0xf bank_mask:0xf
    v_cndmask_b32_dpp v215, v55, v51, vcc quad_perm:[1,0,3,2] row_mask:0xf bank_mask:0xf
    v_cndmask_b32_dpp v223, v63, v59, vcc quad_perm:[1,0,3,2] row_mask:0xf bank_mask:0xf
    ds_read_b64_tr_b16 v[180:181], v198 offset:35864
    ds_read_b64_tr_b16 v[182:183], v198 offset:38424
    s_waitcnt lgkmcnt(12)
    v_mfma_f32_16x16x32_bf16 v[108:111], v[156:159], v[40:43], v[108:111]
    v_mfma_f32_16x16x32_bf16 v[228:231], v[40:43], v[40:43], v[228:231]
    s_mov_b32 vcc_lo, 0xaaaaaaaa
    s_mov_b32 vcc_hi, 0xaaaaaaaa
    v_cndmask_b32_dpp v216, v48, v52, vcc quad_perm:[1,0,3,2] row_mask:0xf bank_mask:0xf
    v_cndmask_b32_dpp v224, v56, v60, vcc quad_perm:[1,0,3,2] row_mask:0xf bank_mask:0xf
    ds_read_b64_tr_b16 v[184:185], v198 offset:35872
    ds_read_b64_tr_b16 v[186:187], v198 offset:38432
    s_waitcnt lgkmcnt(12)
    v_mfma_f32_16x16x32_bf16 v[112:115], v[160:163], v[40:43], v[112:115]
    v_cndmask_b32_dpp v217, v49, v53, vcc quad_perm:[1,0,3,2] row_mask:0xf bank_mask:0xf
    v_cndmask_b32_dpp v225, v57, v61, vcc quad_perm:[1,0,3,2] row_mask:0xf bank_mask:0xf
    v_cndmask_b32_dpp v218, v50, v54, vcc quad_perm:[1,0,3,2] row_mask:0xf bank_mask:0xf
    ds_read_b64_tr_b16 v[188:189], v200 offset:7168
    ds_read_b64_tr_b16 v[190:191], v200 offset:7680
    s_waitcnt lgkmcnt(12)
    v_mfma_f32_16x16x32_bf16 v[116:119], v[164:167], v[40:43], v[116:119]
    v_cndmask_b32_dpp v226, v58, v62, vcc quad_perm:[1,0,3,2] row_mask:0xf bank_mask:0xf
    v_cndmask_b32_dpp v219, v51, v55, vcc quad_perm:[1,0,3,2] row_mask:0xf bank_mask:0xf
    v_cndmask_b32_dpp v227, v59, v63, vcc quad_perm:[1,0,3,2] row_mask:0xf bank_mask:0xf
    s_cmp_lg_u32 s3, 2
    s_cbranch_scc1 l1_kernel_cs6
    v_mfma_f32_16x16x32_bf16 v[120:123], v[144:147], v[204:207], v[120:123]
    v_mfma_f32_16x16x32_bf16 v[124:127], v[148:151], v[204:207], v[124:127]
    v_mfma_f32_16x16x32_bf16 v[128:131], v[152:155], v[204:207], v[128:131]
    v_mfma_f32_16x16x32_bf16 v[132:135], v[156:159], v[204:207], v[132:135]
    v_mfma_f32_16x16x32_bf16 v[136:139], v[160:163], v[204:207], v[136:139]
    v_mfma_f32_16x16x32_bf16 v[140:143], v[164:167], v[204:207], v[140:143]
l1_kernel_cs6:
    s_waitcnt vmcnt(9)
    s_barrier
    s_lshl_b32 s12, s68, 8
    s_mul_i32 s13, s68, 163840
    s_add_u32 s12, s12, s6
    s_add_u32 s13, s13, s8
    ds_read_b64_tr_b16 v[144:145], v198 offset:40960
    ds_read_b64_tr_b16 v[146:147], v198 offset:43520
    s_waitcnt lgkmcnt(12)
    v_mfma_f32_16x16x32_bf16 v[96:99], v[168:171], v[44:47], v[96:99]
    buffer_load_dwordx4 v[80:83], v197, s[44:47], s12 offen offset:0
    s_mov_b32 vcc_lo, 0x33333333
    s_mov_b32 vcc_hi, 0x33333333
    v_cndmask_b32_dpp v48, v220, v212, vcc quad_perm:[2,3,0,1] row_mask:0xf bank_mask:0xf
    v_cndmask_b32_dpp v52, v224, v216, vcc quad_perm:[2,3,0,1] row_mask:0xf bank_mask:0xf
    ds_read_b64_tr_b16 v[148:149], v198 offset:40968
    ds_read_b64_tr_b16 v[150:151], v198 offset:43528
    s_waitcnt lgkmcnt(12)
    v_mfma_f32_16x16x32_bf16 v[100:103], v[172:175], v[44:47], v[100:103]
    v_mfma_f32_16x16x32_bf16 v[208:211], v[204:207], v[44:47], v[208:211]
    v_cndmask_b32_dpp v49, v221, v213, vcc quad_perm:[2,3,0,1] row_mask:0xf bank_mask:0xf
    v_cndmask_b32_dpp v53, v225, v217, vcc quad_perm:[2,3,0,1] row_mask:0xf bank_mask:0xf
    v_cndmask_b32_dpp v50, v222, v214, vcc quad_perm:[2,3,0,1] row_mask:0xf bank_mask:0xf
    ds_read_b64_tr_b16 v[152:153], v198 offset:40976
    ds_read_b64_tr_b16 v[154:155], v198 offset:43536
    s_waitcnt lgkmcnt(12)
    v_mfma_f32_16x16x32_bf16 v[104:107], v[176:179], v[44:47], v[104:107]
    buffer_load_dwordx4 v[84:87], v197, s[44:47], s12 offen offset:1280
    v_cndmask_b32_dpp v54, v226, v218, vcc quad_perm:[2,3,0,1] row_mask:0xf bank_mask:0xf
    v_cndmask_b32_dpp v51, v223, v215, vcc quad_perm:[2,3,0,1] row_mask:0xf bank_mask:0xf
    v_cndmask_b32_dpp v55, v227, v219, vcc quad_perm:[2,3,0,1] row_mask:0xf bank_mask:0xf
    ds_read_b64_tr_b16 v[156:157], v198 offset:40984
    ds_read_b64_tr_b16 v[158:159], v198 offset:43544
    s_waitcnt lgkmcnt(12)
    v_mfma_f32_16x16x32_bf16 v[108:111], v[180:183], v[44:47], v[108:111]
    v_mfma_f32_16x16x32_bf16 v[228:231], v[44:47], v[44:47], v[228:231]
    s_mov_b32 vcc_lo, 0xcccccccc
    s_mov_b32 vcc_hi, 0xcccccccc
    v_cndmask_b32_dpp v56, v212, v220, vcc quad_perm:[2,3,0,1] row_mask:0xf bank_mask:0xf
    v_cndmask_b32_dpp v60, v216, v224, vcc quad_perm:[2,3,0,1] row_mask:0xf bank_mask:0xf
    ds_read_b64_tr_b16 v[160:161], v198 offset:40992
    ds_read_b64_tr_b16 v[162:163], v198 offset:43552
    s_waitcnt lgkmcnt(12)
    v_mfma_f32_16x16x32_bf16 v[112:115], v[184:187], v[44:47], v[112:115]
    buffer_load_dwordx4 v[88:91], v197, s[44:47], s12 offen offset:2560
    v_cndmask_b32_dpp v57, v213, v221, vcc quad_perm:[2,3,0,1] row_mask:0xf bank_mask:0xf
    v_cndmask_b32_dpp v61, v217, v225, vcc quad_perm:[2,3,0,1] row_mask:0xf bank_mask:0xf
    v_cndmask_b32_dpp v58, v214, v222, vcc quad_perm:[2,3,0,1] row_mask:0xf bank_mask:0xf
    ds_read_b64_tr_b16 v[164:165], v200 offset:8192
    ds_read_b64_tr_b16 v[166:167], v200 offset:8704
    s_waitcnt lgkmcnt(12)
    v_mfma_f32_16x16x32_bf16 v[116:119], v[188:191], v[44:47], v[116:119]
    v_cndmask_b32_dpp v62, v218, v226, vcc quad_perm:[2,3,0,1] row_mask:0xf bank_mask:0xf
    v_cndmask_b32_dpp v59, v215, v223, vcc quad_perm:[2,3,0,1] row_mask:0xf bank_mask:0xf
    v_cndmask_b32_dpp v63, v219, v227, vcc quad_perm:[2,3,0,1] row_mask:0xf bank_mask:0xf
    s_cmp_lg_u32 s3, 3
    s_cbranch_scc1 l1_kernel_cs7
    v_mfma_f32_16x16x32_bf16 v[120:123], v[168:171], v[204:207], v[120:123]
    v_mfma_f32_16x16x32_bf16 v[124:127], v[172:175], v[204:207], v[124:127]
    v_mfma_f32_16x16x32_bf16 v[128:131], v[176:179], v[204:207], v[128:131]
    v_mfma_f32_16x16x32_bf16 v[132:135], v[180:183], v[204:207], v[132:135]
    v_mfma_f32_16x16x32_bf16 v[136:139], v[184:187], v[204:207], v[136:139]
    v_mfma_f32_16x16x32_bf16 v[140:143], v[188:191], v[204:207], v[140:143]
l1_kernel_cs7:
    ds_read_b64_tr_b16 v[168:169], v198 offset:46080
    ds_read_b64_tr_b16 v[170:171], v198 offset:48640
    s_waitcnt lgkmcnt(12)
    v_mfma_f32_16x16x32_bf16 v[96:99], v[144:147], v[48:51], v[96:99]
    buffer_load_dwordx4 v[92:95], v197, s[44:47], s12 offen offset:3840
    ds_read_b64_tr_b16 v[172:173], v198 offset:46088
    ds_read_b64_tr_b16 v[174:175], v198 offset:48648
    s_waitcnt lgkmcnt(12)
    v_mfma_f32_16x16x32_bf16 v[100:103], v[148:151], v[48:51], v[100:103]
    v_mfma_f32_16x16x32_bf16 v[208:211], v[204:207], v[48:51], v[208:211]
    ds_read_b64_tr_b16 v[176:177], v198 offset:46096
    ds_read_b64_tr_b16 v[178:179], v198 offset:48656
    s_waitcnt lgkmcnt(12)
    v_mfma_f32_16x16x32_bf16 v[104:107], v[152:155], v[48:51], v[104:107]
    s_add_u32 m0, s11, 81920
    s_nop 0
    buffer_load_dwordx4 v192, s[48:51], s13 offen lds
    ds_read_b64_tr_b16 v[180:181], v198 offset:46104
    ds_read_b64_tr_b16 v[182:183], v198 offset:48664
    s_waitcnt lgkmcnt(12)
    v_mfma_f32_16x16x32_bf16 v[108:111], v[156:159], v[48:51], v[108:111]
    v_mfma_f32_16x16x32_bf16 v[228:231], v[48:51], v[48:51], v[228:231]
    ds_read_b64_tr_b16 v[184:185], v198 offset:46112
    ds_read_b64_tr_b16 v[186:187], v198 offset:48672
    s_waitcnt lgkmcnt(12)
    v_mfma_f32_16x16x32_bf16 v[112:115], v[160:163], v[48:51], v[112:115]
    s_add_u32 m0, s11, 82944
    s_nop 0
    buffer_load_dwordx4 v193, s[48:51], s13 offen lds
    ds_read_b64_tr_b16 v[188:189], v200 offset:9216
    ds_read_b64_tr_b16 v[190:191], v200 offset:9728
    s_waitcnt lgkmcnt(12)
    v_mfma_f32_16x16x32_bf16 v[116:119], v[164:167], v[48:51], v[116:119]
    s_cmp_lg_u32 s3, 0
    s_cbranch_scc1 l1_kernel_cs8
    v_mfma_f32_16x16x32_bf16 v[120:123], v[144:147], v[204:207], v[120:123]
    v_mfma_f32_16x16x32_bf16 v[124:127], v[148:151], v[204:207], v[124:127]
    v_mfma_f32_16x16x32_bf16 v[128:131], v[152:155], v[204:207], v[128:131]
    v_mfma_f32_16x16x32_bf16 v[132:135], v[156:159], v[204:207], v[132:135]
    v_mfma_f32_16x16x32_bf16 v[136:139], v[160:163], v[204:207], v[136:139]
    v_mfma_f32_16x16x32_bf16 v[140:143], v[164:167], v[204:207], v[140:143]
l1_kernel_cs8:
    ds_read_b64_tr_b16 v[144:145], v198 offset:51200
    ds_read_b64_tr_b16 v[146:147], v198 offset:53760
    s_waitcnt lgkmcnt(12)
    v_mfma_f32_16x16x32_bf16 v[96:99], v[168:171], v[52:55], v[96:99]
    s_add_u32 m0, s11, 83968
    s_nop 0
    buffer_load_dwordx4 v194, s[48:51], s13 offen lds
    ds_read_b64_tr_b16 v[148:149], v198 offset:51208
    ds_read_b64_tr_b16 v[150:151], v198 offset:53768
    s_waitcnt lgkmcnt(12)
    v_mfma_f32_16x16x32_bf16 v[100:103], v[172:175], v[52:55], v[100:103]
    v_mfma_f32_16x16x32_bf16 v[208:211], v[204:207], v[52:55], v[208:211]
    ds_read_b64_tr_b16 v[152:153], v198 offset:51216
    ds_read_b64_tr_b16 v[154:155], v198 offset:53776
    s_waitcnt lgkmcnt(12)
    v_mfma_f32_16x16x32_bf16 v[104:107], v[176:179], v[52:55], v[104:107]
    s_add_u32 m0, s11, 84992
    s_nop 0
    buffer_load_dwordx4 v195, s[48:51], s13 offen lds
    ds_read_b64_tr_b16 v[156:157], v198 offset:51224
    ds_read_b64_tr_b16 v[158:159], v198 offset:53784
    s_waitcnt lgkmcnt(12)
    v_mfma_f32_16x16x32_bf16 v[108:111], v[180:183], v[52:55], v[108:111]
    v_mfma_f32_16x16x32_bf16 v[228:231], v[52:55], v[52:55], v[228:231]
    ds_read_b64_tr_b16 v[160:161], v198 offset:51232
    ds_read_b64_tr_b16 v[162:163], v198 offset:53792
    s_waitcnt lgkmcnt(12)
    v_mfma_f32_16x16x32_bf16 v[112:115], v[184:187], v[52:55], v[112:115]
    s_add_u32 m0, s11, 86016
    s_nop 0
    buffer_load_dwordx4 v196, s[48:51], s13 offen lds
    ds_read_b64_tr_b16 v[164:165], v200 offset:10240
    ds_read_b64_tr_b16 v[166:167], v200 offset:10752
    s_waitcnt lgkmcnt(12)
    v_mfma_f32_16x16x32_bf16 v[116:119], v[188:191], v[52:55], v[116:119]
    s_cmp_lg_u32 s3, 1
    s_cbranch_scc1 l1_kernel_cs9
    v_mfma_f32_16x16x32_bf16 v[120:123], v[168:171], v[204:207], v[120:123]
    v_mfma_f32_16x16x32_bf16 v[124:127], v[172:175], v[204:207], v[124:127]
    v_mfma_f32_16x16x32_bf16 v[128:131], v[176:179], v[204:207], v[128:131]
    v_mfma_f32_16x16x32_bf16 v[132:135], v[180:183], v[204:207], v[132:135]
    v_mfma_f32_16x16x32_bf16 v[136:139], v[184:187], v[204:207], v[136:139]
    v_mfma_f32_16x16x32_bf16 v[140:143], v[188:191], v[204:207], v[140:143]
l1_kernel_cs9:
    s_waitcnt vmcnt(14)
    ds_read_b64_tr_b16 v[168:169], v198 offset:56320
    ds_read_b64_tr_b16 v[170:171], v198 offset:58880
    s_waitcnt lgkmcnt(12)
    v_mfma_f32_16x16x32_bf16 v[96:99], v[144:147], v[56:59], v[96:99]
    s_mov_b32 vcc_lo, 0x55555555
    s_mov_b32 vcc_hi, 0x55555555
    v_cndmask_b32_dpp v212, v68, v64, vcc quad_perm:[1,0,3,2] row_mask:0xf bank_mask:0xf
    v_cndmask_b32_dpp v220, v76, v72, vcc quad_perm:[1,0,3,2] row_mask:0xf bank_mask:0xf
    ds_read_b64_tr_b16 v[172:173], v198 offset:56328
    ds_read_b64_tr_b16 v[174:175], v198 offset:58888
    s_waitcnt lgkmcnt(12)
    v_mfma_f32_16x16x32_bf16 v[100:103], v[148:151], v[56:59], v[100:103]
    v_mfma_f32_16x16x32_bf16 v[208:211], v[204:207], v[56:59], v[208:211]
    v_cndmask_b32_dpp v213, v69, v65, vcc quad_perm:[1,0,3,2] row_mask:0xf bank_mask:0xf
    v_cndmask_b32_dpp v221, v77, v73, vcc quad_perm:[1,0,3,2] row_mask:0xf bank_mask:0xf
    v_cndmask_b32_dpp v214, v70, v66, vcc quad_perm:[1,0,3,2] row_mask:0xf bank_mask:0xf
    ds_read_b64_tr_b16 v[176:177], v198 offset:56336
    ds_read_b64_tr_b16 v[178:179], v198 offset:58896
    s_waitcnt lgkmcnt(12)
    v_mfma_f32_16x16x32_bf16 v[104:107], v[152:155], v[56:59], v[104:107]
    v_cndmask_b32_dpp v222, v78, v74, vcc quad_perm:[1,0,3,2] row_mask:0xf bank_mask:0xf
    v_cndmask_b32_dpp v215, v71, v67, vcc quad_perm:[1,0,3,2] row_mask:0xf bank_mask:0xf
    v_cndmask_b32_dpp v223, v79, v75, vcc quad_perm:[1,0,3,2] row_mask:0xf bank_mask:0xf
    ds_read_b64_tr_b16 v[180:181], v198 offset:56344
    ds_read_b64_tr_b16 v[182:183], v198 offset:58904
    s_waitcnt lgkmcnt(12)
    v_mfma_f32_16x16x32_bf16 v[108:111], v[156:159], v[56:59], v[108:111]
    v_mfma_f32_16x16x32_bf16 v[228:231], v[56:59], v[56:59], v[228:231]
    s_mov_b32 vcc_lo, 0xaaaaaaaa
    s_mov_b32 vcc_hi, 0xaaaaaaaa
    v_cndmask_b32_dpp v216, v64, v68, vcc quad_perm:[1,0,3,2] row_mask:0xf bank_mask:0xf
    v_cndmask_b32_dpp v224, v72, v76, vcc quad_perm:[1,0,3,2] row_mask:0xf bank_mask:0xf
    ds_read_b64_tr_b16 v[184:185], v198 offset:56352
    ds_read_b64_tr_b16 v[186:187], v198 offset:58912
    s_waitcnt lgkmcnt(12)
    v_mfma_f32_16x16x32_bf16 v[112:115], v[160:163], v[56:59], v[112:115]
    v_cndmask_b32_dpp v217, v65, v69, vcc quad_perm:[1,0,3,2] row_mask:0xf bank_mask:0xf
    v_cndmask_b32_dpp v225, v73, v77, vcc quad_perm:[1,0,3,2] row_mask:0xf bank_mask:0xf
    v_cndmask_b32_dpp v218, v66, v70, vcc quad_perm:[1,0,3,2] row_mask:0xf bank_mask:0xf
    ds_read_b64_tr_b16 v[188:189], v200 offset:11264
    ds_read_b64_tr_b16 v[190:191], v200 offset:11776
    s_waitcnt lgkmcnt(12)
    v_mfma_f32_16x16x32_bf16 v[116:119], v[164:167], v[56:59], v[116:119]
    v_cndmask_b32_dpp v226, v74, v78, vcc quad_perm:[1,0,3,2] row_mask:0xf bank_mask:0xf
    v_cndmask_b32_dpp v219, v67, v71, vcc quad_perm:[1,0,3,2] row_mask:0xf bank_mask:0xf
    v_cndmask_b32_dpp v227, v75, v79, vcc quad_perm:[1,0,3,2] row_mask:0xf bank_mask:0xf
    s_cmp_lg_u32 s3, 2
    s_cbranch_scc1 l1_kernel_cs10
    v_mfma_f32_16x16x32_bf16 v[120:123], v[144:147], v[204:207], v[120:123]
    v_mfma_f32_16x16x32_bf16 v[124:127], v[148:151], v[204:207], v[124:127]
    v_mfma_f32_16x16x32_bf16 v[128:131], v[152:155], v[204:207], v[128:131]
    v_mfma_f32_16x16x32_bf16 v[132:135], v[156:159], v[204:207], v[132:135]
    v_mfma_f32_16x16x32_bf16 v[136:139], v[160:163], v[204:207], v[136:139]
    v_mfma_f32_16x16x32_bf16 v[140:143], v[164:167], v[204:207], v[140:143]
l1_kernel_cs10:
    s_waitcnt vmcnt(9)
    s_barrier
    ds_read_b64_tr_b16 v[144:145], v199 offset:0
    ds_read_b64_tr_b16 v[146:147], v199 offset:2560
    s_waitcnt lgkmcnt(12)
    v_mfma_f32_16x16x32_bf16 v[96:99], v[168:171], v[60:63], v[96:99]
    s_mov_b32 vcc_lo, 0x33333333
    s_mov_b32 vcc_hi, 0x33333333
    v_cndmask_b32_dpp v64, v220, v212, vcc quad_perm:[2,3,0,1] row_mask:0xf bank_mask:0xf
    v_cndmask_b32_dpp v68, v224, v216, vcc quad_perm:[2,3,0,1] row_mask:0xf bank_mask:0xf
    ds_read_b64_tr_b16 v[148:149], v199 offset:8
    ds_read_b64_tr_b16 v[150:151], v199 offset:2568
    s_waitcnt lgkmcnt(12)
    v_mfma_f32_16x16x32_bf16 v[100:103], v[172:175], v[60:63], v[100:103]
    v_mfma_f32_16x16x32_bf16 v[208:211], v[204:207], v[60:63], v[208:211]
    v_cndmask_b32_dpp v65, v221, v213, vcc quad_perm:[2,3,0,1] row_mask:0xf bank_mask:0xf
    v_cndmask_b32_dpp v69, v225, v217, vcc quad_perm:[2,3,0,1] row_mask:0xf bank_mask:0xf
    v_cndmask_b32_dpp v66, v222, v214, vcc quad_perm:[2,3,0,1] row_mask:0xf bank_mask:0xf
    ds_read_b64_tr_b16 v[152:153], v199 offset:16
    ds_read_b64_tr_b16 v[154:155], v199 offset:2576
    s_waitcnt lgkmcnt(12)
    v_mfma_f32_16x16x32_bf16 v[104:107], v[176:179], v[60:63], v[104:107]
    v_cndmask_b32_dpp v70, v226, v218, vcc quad_perm:[2,3,0,1] row_mask:0xf bank_mask:0xf
    v_cndmask_b32_dpp v67, v223, v215, vcc quad_perm:[2,3,0,1] row_mask:0xf bank_mask:0xf
    v_cndmask_b32_dpp v71, v227, v219, vcc quad_perm:[2,3,0,1] row_mask:0xf bank_mask:0xf
    ds_read_b64_tr_b16 v[156:157], v199 offset:24
    ds_read_b64_tr_b16 v[158:159], v199 offset:2584
    s_waitcnt lgkmcnt(12)
    v_mfma_f32_16x16x32_bf16 v[108:111], v[180:183], v[60:63], v[108:111]
    v_mfma_f32_16x16x32_bf16 v[228:231], v[60:63], v[60:63], v[228:231]
    s_mov_b32 vcc_lo, 0xcccccccc
    s_mov_b32 vcc_hi, 0xcccccccc
    v_cndmask_b32_dpp v72, v212, v220, vcc quad_perm:[2,3,0,1] row_mask:0xf bank_mask:0xf
    v_cndmask_b32_dpp v76, v216, v224, vcc quad_perm:[2,3,0,1] row_mask:0xf bank_mask:0xf
    ds_read_b64_tr_b16 v[160:161], v199 offset:32
    ds_read_b64_tr_b16 v[162:163], v199 offset:2592
    s_waitcnt lgkmcnt(12)
    v_mfma_f32_16x16x32_bf16 v[112:115], v[184:187], v[60:63], v[112:115]
    v_cndmask_b32_dpp v73, v213, v221, vcc quad_perm:[2,3,0,1] row_mask:0xf bank_mask:0xf
    v_cndmask_b32_dpp v77, v217, v225, vcc quad_perm:[2,3,0,1] row_mask:0xf bank_mask:0xf
    v_cndmask_b32_dpp v74, v214, v222, vcc quad_perm:[2,3,0,1] row_mask:0xf bank_mask:0xf
    ds_read_b64_tr_b16 v[164:165], v200 offset:12288
    ds_read_b64_tr_b16 v[166:167], v200 offset:12800
    s_waitcnt lgkmcnt(12)
    v_mfma_f32_16x16x32_bf16 v[116:119], v[188:191], v[60:63], v[116:119]
    v_cndmask_b32_dpp v78, v218, v226, vcc quad_perm:[2,3,0,1] row_mask:0xf bank_mask:0xf
    v_cndmask_b32_dpp v75, v215, v223, vcc quad_perm:[2,3,0,1] row_mask:0xf bank_mask:0xf
    v_cndmask_b32_dpp v79, v219, v227, vcc quad_perm:[2,3,0,1] row_mask:0xf bank_mask:0xf
    s_cmp_lg_u32 s3, 3
    s_cbranch_scc1 l1_kernel_cs11
    v_mfma_f32_16x16x32_bf16 v[120:123], v[168:171], v[204:207], v[120:123]
    v_mfma_f32_16x16x32_bf16 v[124:127], v[172:175], v[204:207], v[124:127]
    v_mfma_f32_16x16x32_bf16 v[128:131], v[176:179], v[204:207], v[128:131]
    v_mfma_f32_16x16x32_bf16 v[132:135], v[180:183], v[204:207], v[132:135]
    v_mfma_f32_16x16x32_bf16 v[136:139], v[184:187], v[204:207], v[136:139]
    v_mfma_f32_16x16x32_bf16 v[140:143], v[188:191], v[204:207], v[140:143]
l1_kernel_cs11:
    ds_read_b64_tr_b16 v[168:169], v199 offset:5120
    ds_read_b64_tr_b16 v[170:171], v199 offset:7680
    s_waitcnt lgkmcnt(12)
    v_mfma_f32_16x16x32_bf16 v[96:99], v[144:147], v[64:67], v[96:99]
    ds_read_b64_tr_b16 v[172:173], v199 offset:5128
    ds_read_b64_tr_b16 v[174:175], v199 offset:7688
    s_waitcnt lgkmcnt(12)
    v_mfma_f32_16x16x32_bf16 v[100:103], v[148:151], v[64:67], v[100:103]
    v_mfma_f32_16x16x32_bf16 v[208:211], v[204:207], v[64:67], v[208:211]
    ds_read_b64_tr_b16 v[176:177], v199 offset:5136
    ds_read_b64_tr_b16 v[178:179], v199 offset:7696
    s_waitcnt lgkmcnt(12)
    v_mfma_f32_16x16x32_bf16 v[104:107], v[152:155], v[64:67], v[104:107]
    ds_read_b64_tr_b16 v[180:181], v199 offset:5144
    ds_read_b64_tr_b16 v[182:183], v199 offset:7704
    s_waitcnt lgkmcnt(12)
    v_mfma_f32_16x16x32_bf16 v[108:111], v[156:159], v[64:67], v[108:111]
    v_mfma_f32_16x16x32_bf16 v[228:231], v[64:67], v[64:67], v[228:231]
    ds_read_b64_tr_b16 v[184:185], v199 offset:5152
    ds_read_b64_tr_b16 v[186:187], v199 offset:7712
    s_waitcnt lgkmcnt(12)
    v_mfma_f32_16x16x32_bf16 v[112:115], v[160:163], v[64:67], v[112:115]
    ds_read_b64_tr_b16 v[188:189], v200 offset:13312
    ds_read_b64_tr_b16 v[190:191], v200 offset:13824
    s_waitcnt lgkmcnt(12)
    v_mfma_f32_16x16x32_bf16 v[116:119], v[164:167], v[64:67], v[116:119]
    s_cmp_lg_u32 s3, 0
    s_cbranch_scc1 l1_kernel_cs12
    v_mfma_f32_16x16x32_bf16 v[120:123], v[144:147], v[204:207], v[120:123]
    v_mfma_f32_16x16x32_bf16 v[124:127], v[148:151], v[204:207], v[124:127]
    v_mfma_f32_16x16x32_bf16 v[128:131], v[152:155], v[204:207], v[128:131]
    v_mfma_f32_16x16x32_bf16 v[132:135], v[156:159], v[204:207], v[132:135]
    v_mfma_f32_16x16x32_bf16 v[136:139], v[160:163], v[204:207], v[136:139]
    v_mfma_f32_16x16x32_bf16 v[140:143], v[164:167], v[204:207], v[140:143]
l1_kernel_cs12:
    ds_read_b64_tr_b16 v[144:145], v199 offset:10240
    ds_read_b64_tr_b16 v[146:147], v199 offset:12800
    s_waitcnt lgkmcnt(12)
    v_mfma_f32_16x16x32_bf16 v[96:99], v[168:171], v[68:71], v[96:99]
    ds_read_b64_tr_b16 v[148:149], v199 offset:10248
    ds_read_b64_tr_b16 v[150:151], v199 offset:12808
    s_waitcnt lgkmcnt(12)
    v_mfma_f32_16x16x32_bf16 v[100:103], v[172:175], v[68:71], v[100:103]
    v_mfma_f32_16x16x32_bf16 v[208:211], v[204:207], v[68:71], v[208:211]
    ds_read_b64_tr_b16 v[152:153], v199 offset:10256
    ds_read_b64_tr_b16 v[154:155], v199 offset:12816
    s_waitcnt lgkmcnt(12)
    v_mfma_f32_16x16x32_bf16 v[104:107], v[176:179], v[68:71], v[104:107]
    ds_read_b64_tr_b16 v[156:157], v199 offset:10264
    ds_read_b64_tr_b16 v[158:159], v199 offset:12824
    s_waitcnt lgkmcnt(12)
    v_mfma_f32_16x16x32_bf16 v[108:111], v[180:183], v[68:71], v[108:111]
    v_mfma_f32_16x16x32_bf16 v[228:231], v[68:71], v[68:71], v[228:231]
    ds_read_b64_tr_b16 v[160:161], v199 offset:10272
    ds_read_b64_tr_b16 v[162:163], v199 offset:12832
    s_waitcnt lgkmcnt(12)
    v_mfma_f32_16x16x32_bf16 v[112:115], v[184:187], v[68:71], v[112:115]
    ds_read_b64_tr_b16 v[164:165], v200 offset:14336
    ds_read_b64_tr_b16 v[166:167], v200 offset:14848
    s_waitcnt lgkmcnt(12)
    v_mfma_f32_16x16x32_bf16 v[116:119], v[188:191], v[68:71], v[116:119]
    s_cmp_lg_u32 s3, 1
    s_cbranch_scc1 l1_kernel_cs13
    v_mfma_f32_16x16x32_bf16 v[120:123], v[168:171], v[204:207], v[120:123]
    v_mfma_f32_16x16x32_bf16 v[124:127], v[172:175], v[204:207], v[124:127]
    v_mfma_f32_16x16x32_bf16 v[128:131], v[176:179], v[204:207], v[128:131]
    v_mfma_f32_16x16x32_bf16 v[132:135], v[180:183], v[204:207], v[132:135]
    v_mfma_f32_16x16x32_bf16 v[136:139], v[184:187], v[204:207], v[136:139]
    v_mfma_f32_16x16x32_bf16 v[140:143], v[188:191], v[204:207], v[140:143]
l1_kernel_cs13:
    s_waitcnt vmcnt(5)
    ds_read_b64_tr_b16 v[168:169], v199 offset:15360
    ds_read_b64_tr_b16 v[170:171], v199 offset:17920
    s_waitcnt lgkmcnt(12)
    v_mfma_f32_16x16x32_bf16 v[96:99], v[144:147], v[72:75], v[96:99]
    s_mov_b32 vcc_lo, 0x55555555
    s_mov_b32 vcc_hi, 0x55555555
    v_cndmask_b32_dpp v212, v84, v80, vcc quad_perm:[1,0,3,2] row_mask:0xf bank_mask:0xf
    v_cndmask_b32_dpp v220, v92, v88, vcc quad_perm:[1,0,3,2] row_mask:0xf bank_mask:0xf
    ds_read_b64_tr_b16 v[172:173], v199 offset:15368
    ds_read_b64_tr_b16 v[174:175], v199 offset:17928
    s_waitcnt lgkmcnt(12)
    v_mfma_f32_16x16x32_bf16 v[100:103], v[148:151], v[72:75], v[100:103]
    v_mfma_f32_16x16x32_bf16 v[208:211], v[204:207], v[72:75], v[208:211]
    v_cndmask_b32_dpp v213, v85, v81, vcc quad_perm:[1,0,3,2] row_mask:0xf bank_mask:0xf
    v_cndmask_b32_dpp v221, v93, v89, vcc quad_perm:[1,0,3,2] row_mask:0xf bank_mask:0xf
    v_cndmask_b32_dpp v214, v86, v82, vcc quad_perm:[1,0,3,2] row_mask:0xf bank_mask:0xf
    ds_read_b64_tr_b16 v[176:177], v199 offset:15376
    ds_read_b64_tr_b16 v[178:179], v199 offset:17936
    s_waitcnt lgkmcnt(12)
    v_mfma_f32_16x16x32_bf16 v[104:107], v[152:155], v[72:75], v[104:107]
    v_cndmask_b32_dpp v222, v94, v90, vcc quad_perm:[1,0,3,2] row_mask:0xf bank_mask:0xf
    v_cndmask_b32_dpp v215, v87, v83, vcc quad_perm:[1,0,3,2] row_mask:0xf bank_mask:0xf
    v_cndmask_b32_dpp v223, v95, v91, vcc quad_perm:[1,0,3,2] row_mask:0xf bank_mask:0xf
    ds_read_b64_tr_b16 v[180:181], v199 offset:15384
    ds_read_b64_tr_b16 v[182:183], v199 offset:17944
    s_waitcnt lgkmcnt(12)
    v_mfma_f32_16x16x32_bf16 v[108:111], v[156:159], v[72:75], v[108:111]
    v_mfma_f32_16x16x32_bf16 v[228:231], v[72:75], v[72:75], v[228:231]
    s_mov_b32 vcc_lo, 0xaaaaaaaa
    s_mov_b32 vcc_hi, 0xaaaaaaaa
    v_cndmask_b32_dpp v216, v80, v84, vcc quad_perm:[1,0,3,2] row_mask:0xf bank_mask:0xf
    v_cndmask_b32_dpp v224, v88, v92, vcc quad_perm:[1,0,3,2] row_mask:0xf bank_mask:0xf
    ds_read_b64_tr_b16 v[184:185], v199 offset:15392
    ds_read_b64_tr_b16 v[186:187], v199 offset:17952
    s_waitcnt lgkmcnt(12)
    v_mfma_f32_16x16x32_bf16 v[112:115], v[160:163], v[72:75], v[112:115]
    v_cndmask_b32_dpp v217, v81, v85, vcc quad_perm:[1,0,3,2] row_mask:0xf bank_mask:0xf
    v_cndmask_b32_dpp v225, v89, v93, vcc quad_perm:[1,0,3,2] row_mask:0xf bank_mask:0xf
    v_cndmask_b32_dpp v218, v82, v86, vcc quad_perm:[1,0,3,2] row_mask:0xf bank_mask:0xf
    ds_read_b64_tr_b16 v[188:189], v200 offset:15360
    ds_read_b64_tr_b16 v[190:191], v200 offset:15872
    s_waitcnt lgkmcnt(12)
    v_mfma_f32_16x16x32_bf16 v[116:119], v[164:167], v[72:75], v[116:119]
    v_cndmask_b32_dpp v226, v90, v94, vcc quad_perm:[1,0,3,2] row_mask:0xf bank_mask:0xf
    v_cndmask_b32_dpp v219, v83, v87, vcc quad_perm:[1,0,3,2] row_mask:0xf bank_mask:0xf
    v_cndmask_b32_dpp v227, v91, v95, vcc quad_perm:[1,0,3,2] row_mask:0xf bank_mask:0xf
    s_cmp_lg_u32 s3, 2
    s_cbranch_scc1 l1_kernel_cs14
    v_mfma_f32_16x16x32_bf16 v[120:123], v[144:147], v[204:207], v[120:123]
    v_mfma_f32_16x16x32_bf16 v[124:127], v[148:151], v[204:207], v[124:127]
    v_mfma_f32_16x16x32_bf16 v[128:131], v[152:155], v[204:207], v[128:131]
    v_mfma_f32_16x16x32_bf16 v[132:135], v[156:159], v[204:207], v[132:135]
    v_mfma_f32_16x16x32_bf16 v[136:139], v[160:163], v[204:207], v[136:139]
    v_mfma_f32_16x16x32_bf16 v[140:143], v[164:167], v[204:207], v[140:143]
l1_kernel_cs14:
    s_waitcnt vmcnt(0)
    s_barrier
    ds_read_b64_tr_b16 v[144:145], v199 offset:20480
    ds_read_b64_tr_b16 v[146:147], v199 offset:23040
    s_waitcnt lgkmcnt(12)
    v_mfma_f32_16x16x32_bf16 v[96:99], v[168:171], v[76:79], v[96:99]
    s_mov_b32 vcc_lo, 0x33333333
    s_mov_b32 vcc_hi, 0x33333333
    v_cndmask_b32_dpp v80, v220, v212, vcc quad_perm:[2,3,0,1] row_mask:0xf bank_mask:0xf
    v_cndmask_b32_dpp v84, v224, v216, vcc quad_perm:[2,3,0,1] row_mask:0xf bank_mask:0xf
    ds_read_b64_tr_b16 v[148:149], v199 offset:20488
    ds_read_b64_tr_b16 v[150:151], v199 offset:23048
    s_waitcnt lgkmcnt(12)
    v_mfma_f32_16x16x32_bf16 v[100:103], v[172:175], v[76:79], v[100:103]
    v_mfma_f32_16x16x32_bf16 v[208:211], v[204:207], v[76:79], v[208:211]
    v_cndmask_b32_dpp v81, v221, v213, vcc quad_perm:[2,3,0,1] row_mask:0xf bank_mask:0xf
    v_cndmask_b32_dpp v85, v225, v217, vcc quad_perm:[2,3,0,1] row_mask:0xf bank_mask:0xf
    v_cndmask_b32_dpp v82, v222, v214, vcc quad_perm:[2,3,0,1] row_mask:0xf bank_mask:0xf
    ds_read_b64_tr_b16 v[152:153], v199 offset:20496
    ds_read_b64_tr_b16 v[154:155], v199 offset:23056
    s_waitcnt lgkmcnt(12)
    v_mfma_f32_16x16x32_bf16 v[104:107], v[176:179], v[76:79], v[104:107]
    v_cndmask_b32_dpp v86, v226, v218, vcc quad_perm:[2,3,0,1] row_mask:0xf bank_mask:0xf
    v_cndmask_b32_dpp v83, v223, v215, vcc quad_perm:[2,3,0,1] row_mask:0xf bank_mask:0xf
    v_cndmask_b32_dpp v87, v227, v219, vcc quad_perm:[2,3,0,1] row_mask:0xf bank_mask:0xf
    ds_read_b64_tr_b16 v[156:157], v199 offset:20504
    ds_read_b64_tr_b16 v[158:159], v199 offset:23064
    s_waitcnt lgkmcnt(12)
    v_mfma_f32_16x16x32_bf16 v[108:111], v[180:183], v[76:79], v[108:111]
    v_mfma_f32_16x16x32_bf16 v[228:231], v[76:79], v[76:79], v[228:231]
    s_mov_b32 vcc_lo, 0xcccccccc
    s_mov_b32 vcc_hi, 0xcccccccc
    v_cndmask_b32_dpp v88, v212, v220, vcc quad_perm:[2,3,0,1] row_mask:0xf bank_mask:0xf
    v_cndmask_b32_dpp v92, v216, v224, vcc quad_perm:[2,3,0,1] row_mask:0xf bank_mask:0xf
    ds_read_b64_tr_b16 v[160:161], v199 offset:20512
    ds_read_b64_tr_b16 v[162:163], v199 offset:23072
    s_waitcnt lgkmcnt(12)
    v_mfma_f32_16x16x32_bf16 v[112:115], v[184:187], v[76:79], v[112:115]
    v_cndmask_b32_dpp v89, v213, v221, vcc quad_perm:[2,3,0,1] row_mask:0xf bank_mask:0xf
    v_cndmask_b32_dpp v93, v217, v225, vcc quad_perm:[2,3,0,1] row_mask:0xf bank_mask:0xf
    v_cndmask_b32_dpp v90, v214, v222, vcc quad_perm:[2,3,0,1] row_mask:0xf bank_mask:0xf
    ds_read_b64_tr_b16 v[164:165], v200 offset:16384
    ds_read_b64_tr_b16 v[166:167], v200 offset:16896
    s_waitcnt lgkmcnt(12)
    v_mfma_f32_16x16x32_bf16 v[116:119], v[188:191], v[76:79], v[116:119]
    v_cndmask_b32_dpp v94, v218, v226, vcc quad_perm:[2,3,0,1] row_mask:0xf bank_mask:0xf
    v_cndmask_b32_dpp v91, v215, v223, vcc quad_perm:[2,3,0,1] row_mask:0xf bank_mask:0xf
    v_cndmask_b32_dpp v95, v219, v227, vcc quad_perm:[2,3,0,1] row_mask:0xf bank_mask:0xf
    s_cmp_lg_u32 s3, 3
    s_cbranch_scc1 l1_kernel_cs15
    v_mfma_f32_16x16x32_bf16 v[120:123], v[168:171], v[204:207], v[120:123]
    v_mfma_f32_16x16x32_bf16 v[124:127], v[172:175], v[204:207], v[124:127]
    v_mfma_f32_16x16x32_bf16 v[128:131], v[176:179], v[204:207], v[128:131]
    v_mfma_f32_16x16x32_bf16 v[132:135], v[180:183], v[204:207], v[132:135]
    v_mfma_f32_16x16x32_bf16 v[136:139], v[184:187], v[204:207], v[136:139]
    v_mfma_f32_16x16x32_bf16 v[140:143], v[188:191], v[204:207], v[140:143]
l1_kernel_cs15:
    ds_read_b64_tr_b16 v[168:169], v199 offset:25600
    ds_read_b64_tr_b16 v[170:171], v199 offset:28160
    s_waitcnt lgkmcnt(12)
    v_mfma_f32_16x16x32_bf16 v[96:99], v[144:147], v[80:83], v[96:99]
    ds_read_b64_tr_b16 v[172:173], v199 offset:25608
    ds_read_b64_tr_b16 v[174:175], v199 offset:28168
    s_waitcnt lgkmcnt(12)
    v_mfma_f32_16x16x32_bf16 v[100:103], v[148:151], v[80:83], v[100:103]
    v_mfma_f32_16x16x32_bf16 v[208:211], v[204:207], v[80:83], v[208:211]
    ds_read_b64_tr_b16 v[176:177], v199 offset:25616
    ds_read_b64_tr_b16 v[178:179], v199 offset:28176
    s_waitcnt lgkmcnt(12)
    v_mfma_f32_16x16x32_bf16 v[104:107], v[152:155], v[80:83], v[104:107]
    ds_read_b64_tr_b16 v[180:181], v199 offset:25624
    ds_read_b64_tr_b16 v[182:183], v199 offset:28184
    s_waitcnt lgkmcnt(12)
    v_mfma_f32_16x16x32_bf16 v[108:111], v[156:159], v[80:83], v[108:111]
    v_mfma_f32_16x16x32_bf16 v[228:231], v[80:83], v[80:83], v[228:231]
    ds_read_b64_tr_b16 v[184:185], v199 offset:25632
    ds_read_b64_tr_b16 v[186:187], v199 offset:28192
    s_waitcnt lgkmcnt(12)
    v_mfma_f32_16x16x32_bf16 v[112:115], v[160:163], v[80:83], v[112:115]
    ds_read_b64_tr_b16 v[188:189], v200 offset:17408
    ds_read_b64_tr_b16 v[190:191], v200 offset:17920
    s_waitcnt lgkmcnt(12)
    v_mfma_f32_16x16x32_bf16 v[116:119], v[164:167], v[80:83], v[116:119]
    s_cmp_lg_u32 s3, 0
    s_cbranch_scc1 l1_kernel_cs16
    v_mfma_f32_16x16x32_bf16 v[120:123], v[144:147], v[204:207], v[120:123]
    v_mfma_f32_16x16x32_bf16 v[124:127], v[148:151], v[204:207], v[124:127]
    v_mfma_f32_16x16x32_bf16 v[128:131], v[152:155], v[204:207], v[128:131]
    v_mfma_f32_16x16x32_bf16 v[132:135], v[156:159], v[204:207], v[132:135]
    v_mfma_f32_16x16x32_bf16 v[136:139], v[160:163], v[204:207], v[136:139]
    v_mfma_f32_16x16x32_bf16 v[140:143], v[164:167], v[204:207], v[140:143]
l1_kernel_cs16:
    ds_read_b64_tr_b16 v[144:145], v199 offset:30720
    ds_read_b64_tr_b16 v[146:147], v199 offset:33280
    s_waitcnt lgkmcnt(12)
    v_mfma_f32_16x16x32_bf16 v[96:99], v[168:171], v[84:87], v[96:99]
    ds_read_b64_tr_b16 v[148:149], v199 offset:30728
    ds_read_b64_tr_b16 v[150:151], v199 offset:33288
    s_waitcnt lgkmcnt(12)
    v_mfma_f32_16x16x32_bf16 v[100:103], v[172:175], v[84:87], v[100:103]
    v_mfma_f32_16x16x32_bf16 v[208:211], v[204:207], v[84:87], v[208:211]
    ds_read_b64_tr_b16 v[152:153], v199 offset:30736
    ds_read_b64_tr_b16 v[154:155], v199 offset:33296
    s_waitcnt lgkmcnt(12)
    v_mfma_f32_16x16x32_bf16 v[104:107], v[176:179], v[84:87], v[104:107]
    ds_read_b64_tr_b16 v[156:157], v199 offset:30744
    ds_read_b64_tr_b16 v[158:159], v199 offset:33304
    s_waitcnt lgkmcnt(12)
    v_mfma_f32_16x16x32_bf16 v[108:111], v[180:183], v[84:87], v[108:111]
    v_mfma_f32_16x16x32_bf16 v[228:231], v[84:87], v[84:87], v[228:231]
    ds_read_b64_tr_b16 v[160:161], v199 offset:30752
    ds_read_b64_tr_b16 v[162:163], v199 offset:33312
    s_waitcnt lgkmcnt(12)
    v_mfma_f32_16x16x32_bf16 v[112:115], v[184:187], v[84:87], v[112:115]
    ds_read_b64_tr_b16 v[164:165], v200 offset:18432
    ds_read_b64_tr_b16 v[166:167], v200 offset:18944
    s_waitcnt lgkmcnt(12)
    v_mfma_f32_16x16x32_bf16 v[116:119], v[188:191], v[84:87], v[116:119]
    s_cmp_lg_u32 s3, 1
    s_cbranch_scc1 l1_kernel_cs17
    v_mfma_f32_16x16x32_bf16 v[120:123], v[168:171], v[204:207], v[120:123]
    v_mfma_f32_16x16x32_bf16 v[124:127], v[172:175], v[204:207], v[124:127]
    v_mfma_f32_16x16x32_bf16 v[128:131], v[176:179], v[204:207], v[128:131]
    v_mfma_f32_16x16x32_bf16 v[132:135], v[180:183], v[204:207], v[132:135]
    v_mfma_f32_16x16x32_bf16 v[136:139], v[184:187], v[204:207], v[136:139]
    v_mfma_f32_16x16x32_bf16 v[140:143], v[188:191], v[204:207], v[140:143]
l1_kernel_cs17:
    ds_read_b64_tr_b16 v[168:169], v199 offset:35840
    ds_read_b64_tr_b16 v[170:171], v199 offset:38400
    s_waitcnt lgkmcnt(12)
    v_mfma_f32_16x16x32_bf16 v[96:99], v[144:147], v[88:91], v[96:99]
    ds_read_b64_tr_b16 v[172:173], v199 offset:35848
    ds_read_b64_tr_b16 v[174:175], v199 offset:38408
    s_waitcnt lgkmcnt(12)
    v_mfma_f32_16x16x32_bf16 v[100:103], v[148:151], v[88:91], v[100:103]
    v_mfma_f32_16x16x32_bf16 v[208:211], v[204:207], v[88:91], v[208:211]
    ds_read_b64_tr_b16 v[176:177], v199 offset:35856
    ds_read_b64_tr_b16 v[178:179], v199 offset:38416
    s_waitcnt lgkmcnt(12)
    v_mfma_f32_16x16x32_bf16 v[104:107], v[152:155], v[88:91], v[104:107]
    ds_read_b64_tr_b16 v[180:181], v199 offset:35864
    ds_read_b64_tr_b16 v[182:183], v199 offset:38424
    s_waitcnt lgkmcnt(12)
    v_mfma_f32_16x16x32_bf16 v[108:111], v[156:159], v[88:91], v[108:111]
    v_mfma_f32_16x16x32_bf16 v[228:231], v[88:91], v[88:91], v[228:231]
    ds_read_b64_tr_b16 v[184:185], v199 offset:35872
    ds_read_b64_tr_b16 v[186:187], v199 offset:38432
    s_waitcnt lgkmcnt(12)
    v_mfma_f32_16x16x32_bf16 v[112:115], v[160:163], v[88:91], v[112:115]
    ds_read_b64_tr_b16 v[188:189], v200 offset:19456
    ds_read_b64_tr_b16 v[190:191], v200 offset:19968
    s_waitcnt lgkmcnt(12)
    v_mfma_f32_16x16x32_bf16 v[116:119], v[164:167], v[88:91], v[116:119]
    s_cmp_lg_u32 s3, 2
    s_cbranch_scc1 l1_kernel_cs18
    v_mfma_f32_16x16x32_bf16 v[120:123], v[144:147], v[204:207], v[120:123]
    v_mfma_f32_16x16x32_bf16 v[124:127], v[148:151], v[204:207], v[124:127]
    v_mfma_f32_16x16x32_bf16 v[128:131], v[152:155], v[204:207], v[128:131]
    v_mfma_f32_16x16x32_bf16 v[132:135], v[156:159], v[204:207], v[132:135]
    v_mfma_f32_16x16x32_bf16 v[136:139], v[160:163], v[204:207], v[136:139]
    v_mfma_f32_16x16x32_bf16 v[140:143], v[164:167], v[204:207], v[140:143]
l1_kernel_cs18:
    s_waitcnt lgkmcnt(10)
    v_mfma_f32_16x16x32_bf16 v[96:99], v[168:171], v[92:95], v[96:99]
    s_waitcnt lgkmcnt(8)
    v_mfma_f32_16x16x32_bf16 v[100:103], v[172:175], v[92:95], v[100:103]
    v_mfma_f32_16x16x32_bf16 v[208:211], v[204:207], v[92:95], v[208:211]
    s_waitcnt lgkmcnt(6)
    v_mfma_f32_16x16x32_bf16 v[104:107], v[176:179], v[92:95], v[104:107]
    s_waitcnt lgkmcnt(4)
    v_mfma_f32_16x16x32_bf16 v[108:111], v[180:183], v[92:95], v[108:111]
    v_mfma_f32_16x16x32_bf16 v[228:231], v[92:95], v[92:95], v[228:231]
    s_waitcnt lgkmcnt(2)
    v_mfma_f32_16x16x32_bf16 v[112:115], v[184:187], v[92:95], v[112:115]
    s_waitcnt lgkmcnt(0)
    v_mfma_f32_16x16x32_bf16 v[116:119], v[188:191], v[92:95], v[116:119]
    s_cmp_lg_u32 s3, 3
    s_cbranch_scc1 l1_kernel_cs19
    v_mfma_f32_16x16x32_bf16 v[120:123], v[168:171], v[204:207], v[120:123]
    v_mfma_f32_16x16x32_bf16 v[124:127], v[172:175], v[204:207], v[124:127]
    v_mfma_f32_16x16x32_bf16 v[128:131], v[176:179], v[204:207], v[128:131]
    v_mfma_f32_16x16x32_bf16 v[132:135], v[180:183], v[204:207], v[132:135]
    v_mfma_f32_16x16x32_bf16 v[136:139], v[184:187], v[204:207], v[136:139]
    v_mfma_f32_16x16x32_bf16 v[140:143], v[188:191], v[204:207], v[140:143]
l1_kernel_cs19:
    v_lshrrev_b32 v3, 4, v0
    s_mul_i32 s8, s3, 384
    v_lshlrev_b32 v4, 4, v3
    v_add_u32 v4, 122880, v4
    v_add_u32 v5, s8, v4
    v_and_b32 v2, 15, v0
    v_lshlrev_b32 v6, 2, v3
    v_sub_u32 v6, v2, v6
    s_mov_b32 exec_lo, 0x00010001
    s_mov_b32 exec_hi, 0x00010001
    s_nop 1
    ds_write_b128 v5, v[120:123] offset:0
    ds_write_b128 v5, v[124:127] offset:64
    ds_write_b128 v5, v[128:131] offset:128
    ds_write_b128 v5, v[132:135] offset:192
    ds_write_b128 v5, v[136:139] offset:256
    ds_write_b128 v5, v[140:143] offset:320
    s_mov_b64 exec, -1
    v_cmp_eq_u32 vcc, 0, v6
    v_cmp_eq_u32 s[12:13], 1, v6
    v_cmp_eq_u32 s[14:15], 2, v6
    v_cndmask_b32 v7, 0, v228, vcc
    v_cmp_eq_u32 vcc, 3, v6
    v_cndmask_b32 v7, v7, v229, s[12:13]
    v_cndmask_b32 v7, v7, v230, s[14:15]
    v_cndmask_b32 v7, v7, v231, vcc
    v_mov_b32 v6, v208
    v_mov_b32 v9, v7
    s_nop 1
    v_permlane32_swap_b32 v7, v9
    v_add_f32 v7, v7, v9
    v_mov_b32 v9, v7
    s_waitcnt lgkmcnt(0)
    s_barrier
    v_permlane16_swap_b32 v7, v9
    ds_read_b128 v[16:19], v4 offset:0
    ds_read_b128 v[20:23], v4 offset:64
    ds_read_b128 v[24:27], v4 offset:128
    ds_read_b128 v[28:31], v4 offset:192
    ds_read_b128 v[32:35], v4 offset:256
    ds_read_b128 v[36:39], v4 offset:320
    ds_read_b128 v[40:43], v4 offset:384
    ds_read_b128 v[44:47], v4 offset:448
    ds_read_b128 v[48:51], v4 offset:512
    ds_read_b128 v[52:55], v4 offset:576
    ds_read_b128 v[56:59], v4 offset:640
    ds_read_b128 v[60:63], v4 offset:704
    ds_read_b128 v[64:67], v4 offset:768
    ds_read_b128 v[68:71], v4 offset:832
    ds_read_b128 v[72:75], v4 offset:896
    ds_read_b128 v[76:79], v4 offset:960
    ds_read_b128 v[80:83], v4 offset:1024
    ds_read_b128 v[84:87], v4 offset:1088
    ds_read_b128 v[120:123], v4 offset:1152
    ds_read_b128 v[124:127], v4 offset:1216
    ds_read_b128 v[128:131], v4 offset:1280
    ds_read_b128 v[132:135], v4 offset:1344
    ds_read_b128 v[136:139], v4 offset:1408
    ds_read_b128 v[140:143], v4 offset:1472
    v_add_f32 v7, v7, v9
    v_mov_b32 v10, 0x3acccccd
    v_mov_b32 v11, 0x44200000
    v_mul_f32 v8, v6, v10
    v_fma_f32 v9, -v8, v11, v6
    v_mul_f32 v9, v9, v10
    v_fma_f32 v7, -v6, v8, v7
    v_fma_f32 v7, -v6, v9, v7
    v_mul_f32 v7, v7, v10
    v_max_f32 v7, 0, v7
    v_cvt_pk_bf16_f32 v8, v8, v7
    v_and_b32 v7, 0xffff0000, v8
    v_lshlrev_b32 v8, 16, v8
    v_add_f32 v7, 0x3727c5ac, v7
    v_cvt_pk_bf16_f32 v7, v7, v7
    v_lshlrev_b32 v7, 16, v7
    v_sqrt_f32 v7, v7
    s_nop 0
    v_cvt_pk_bf16_f32 v7, v7, v7
    v_lshlrev_b32 v7, 16, v7
    v_rcp_f32 v7, v7
    v_mul_u32_u24 v12, 2560, v3
    v_mul_f32 v9, 0x3ea52b5c, v7
    v_lshl_add_u32 v13, v2, 3, v12
    v_lshl_add_u32 v12, v2, 4, v12
    s_lshl_b32 s8, s4, 3
    s_add_u32 s8, s8, s5
    s_mul_i32 s8, s8, 10240
    s_lshr_b32 s9, s3, 1
    s_mul_i32 s9, s9, 1280
    s_add_u32 s8, s8, s9
    s_and_b32 s9, s3, 1
    s_lshl_b32 s9, s9, 7
    s_add_u32 s10, s8, s9
    s_add_u32 s8, s10, s9
    s_waitcnt lgkmcnt(0)
    v_add_f32 v120, v120, v16
    v_add_f32 v10, v40, v64
    v_add_f32 v120, v120, v10
    v_fma_f32 v96, -v8, v120, v96
    v_mul_f32 v96, v96, v9
    v_add_f32 v121, v121, v17
    v_add_f32 v10, v41, v65
    v_add_f32 v121, v121, v10
    v_fma_f32 v97, -v8, v121, v97
    v_mul_f32 v97, v97, v9
    v_add_f32 v122, v122, v18
    v_add_f32 v10, v42, v66
    v_add_f32 v122, v122, v10
    v_fma_f32 v98, -v8, v122, v98
    v_mul_f32 v98, v98, v9
    v_add_f32 v123, v123, v19
    v_add_f32 v10, v43, v67
    v_add_f32 v123, v123, v10
    v_fma_f32 v99, -v8, v123, v99
    v_mul_f32 v99, v99, v9
    v_cvt_pk_bf16_f32 v144, v96, v97
    v_cvt_pk_bf16_f32 v145, v98, v99
    v_add_f32 v124, v124, v20
    v_add_f32 v10, v44, v68
    v_add_f32 v124, v124, v10
    v_fma_f32 v100, -v8, v124, v100
    v_mul_f32 v100, v100, v9
    v_add_f32 v125, v125, v21
    v_add_f32 v10, v45, v69
    v_add_f32 v125, v125, v10
    v_fma_f32 v101, -v8, v125, v101
    v_mul_f32 v101, v101, v9
    v_add_f32 v126, v126, v22
    v_add_f32 v10, v46, v70
    v_add_f32 v126, v126, v10
    v_fma_f32 v102, -v8, v126, v102
    v_mul_f32 v102, v102, v9
    v_add_f32 v127, v127, v23
    v_add_f32 v10, v47, v71
    v_add_f32 v127, v127, v10
    v_fma_f32 v103, -v8, v127, v103
    v_mul_f32 v103, v103, v9
    v_cvt_pk_bf16_f32 v146, v100, v101
    v_cvt_pk_bf16_f32 v147, v102, v103
    buffer_store_dwordx4 v[144:147], v12, s[52:55], s8 offen
    v_add_f32 v128, v128, v24
    v_add_f32 v10, v48, v72
    v_add_f32 v128, v128, v10
    v_fma_f32 v104, -v8, v128, v104
    v_mul_f32 v104, v104, v9
    v_add_f32 v129, v129, v25
    v_add_f32 v10, v49, v73
    v_add_f32 v129, v129, v10
    v_fma_f32 v105, -v8, v129, v105
    v_mul_f32 v105, v105, v9
    v_add_f32 v130, v130, v26
    v_add_f32 v10, v50, v74
    v_add_f32 v130, v130, v10
    v_fma_f32 v106, -v8, v130, v106
    v_mul_f32 v106, v106, v9
    v_add_f32 v131, v131, v27
    v_add_f32 v10, v51, v75
    v_add_f32 v131, v131, v10
    v_fma_f32 v107, -v8, v131, v107
    v_mul_f32 v107, v107, v9
    v_cvt_pk_bf16_f32 v148, v104, v105
    v_cvt_pk_bf16_f32 v149, v106, v107
    v_add_f32 v132, v132, v28
    v_add_f32 v10, v52, v76
    v_add_f32 v132, v132, v10
    v_fma_f32 v108, -v8, v132, v108
    v_mul_f32 v108, v108, v9
    v_add_f32 v133, v133, v29
    v_add_f32 v10, v53, v77
    v_add_f32 v133, v133, v10
    v_fma_f32 v109, -v8, v133, v109
    v_mul_f32 v109, v109, v9
    v_add_f32 v134, v134, v30
    v_add_f32 v10, v54, v78
    v_add_f32 v134, v134, v10
    v_fma_f32 v110, -v8, v134, v110
    v_mul_f32 v110, v110, v9
    v_add_f32 v135, v135, v31
    v_add_f32 v10, v55, v79
    v_add_f32 v135, v135, v10
    v_fma_f32 v111, -v8, v135, v111
    v_mul_f32 v111, v111, v9
    v_cvt_pk_bf16_f32 v150, v108, v109
    v_cvt_pk_bf16_f32 v151, v110, v111
    buffer_store_dwordx4 v[148:151], v12, s[52:55], s8 offen offset:512
    v_add_f32 v136, v136, v32
    v_add_f32 v10, v56, v80
    v_add_f32 v136, v136, v10
    v_fma_f32 v112, -v8, v136, v112
    v_mul_f32 v112, v112, v9
    v_add_f32 v137, v137, v33
    v_add_f32 v10, v57, v81
    v_add_f32 v137, v137, v10
    v_fma_f32 v113, -v8, v137, v113
    v_mul_f32 v113, v113, v9
    v_add_f32 v138, v138, v34
    v_add_f32 v10, v58, v82
    v_add_f32 v138, v138, v10
    v_fma_f32 v114, -v8, v138, v114
    v_mul_f32 v114, v114, v9
    v_add_f32 v139, v139, v35
    v_add_f32 v10, v59, v83
    v_add_f32 v139, v139, v10
    v_fma_f32 v115, -v8, v139, v115
    v_mul_f32 v115, v115, v9
    v_cvt_pk_bf16_f32 v152, v112, v113
    v_cvt_pk_bf16_f32 v153, v114, v115
    buffer_store_dwordx2 v[152:153], v13, s[52:55], s10 offen offset:1024
    v_add_f32 v140, v140, v36
    v_add_f32 v10, v60, v84
    v_add_f32 v140, v140, v10
    v_fma_f32 v116, -v8, v140, v116
    v_mul_f32 v116, v116, v7
    v_add_f32 v141, v141, v37
    v_add_f32 v10, v61, v85
    v_add_f32 v141, v141, v10
    v_fma_f32 v117, -v8, v141, v117
    v_mul_f32 v117, v117, v7
    v_add_f32 v142, v142, v38
    v_add_f32 v10, v62, v86
    v_add_f32 v142, v142, v10
    v_fma_f32 v118, -v8, v142, v118
    v_mul_f32 v118, v118, v7
    v_add_f32 v143, v143, v39
    v_add_f32 v10, v63, v87
    v_add_f32 v143, v143, v10
    v_fma_f32 v119, -v8, v143, v119
    v_mul_f32 v119, v119, v7
    v_cvt_pk_bf16_f32 v116, v116, v117
    v_cvt_pk_bf16_f32 v117, v118, v119
    s_cmp_lg_u32 s5, 4
    s_cbranch_scc1 l1_kernel_nost
    v_mov_b32 v10, v8
    v_mov_b32 v11, v7
    v_lshlrev_b32 v4, 3, v2
    s_lshl_b32 s7, s7, 3
    s_add_u32 s7, s7, 5242880
    s_mov_b64 exec, 0xffff
    buffer_store_dwordx2 v[10:11], v4, s[52:55], s7 offen
    s_endpgm
l1_kernel_nost:
    s_cmp_lg_u32 s5, 5
    s_cbranch_scc1 l1_kernel_noz
    s_cmp_ge_u32 s4, 5
    s_cbranch_scc1 l1_kernel_end
    s_lshl_b32 s7, s7, 6
    s_add_u32 s7, s7, 8060928
    v_lshlrev_b32 v4, 4, v0
    v_mov_b32 v8, 0
    v_mov_b32 v9, 0
    v_mov_b32 v10, 0
    v_mov_b32 v11, 0
    buffer_store_dwordx4 v[8:11], v4, s[52:55], s7 offen
    s_endpgm
l1_kernel_noz:
    s_cmp_ge_u32 s5, 4
    s_cbranch_scc1 l1_kernel_end
    s_lshr_b32 s7, s4, 1
    s_mul_i32 s7, s7, 10240
    s_add_u32 s7, s7, 7864320
    s_and_b32 s8, s4, 1
    s_cmp_eq_u32 s5, 3
    s_cbranch_scc1 l1_kernel_e3
    s_cmp_eq_u32 s5, 0
    s_cbranch_scc0 l1_kernel_e12
    s_lshl_b32 s8, s8, 11
    s_lshl_b32 s9, s3, 8
    s_and_b32 s10, s9, 0x200
    s_add_u32 s9, s9, s10
    s_add_u32 s7, s7, s8
    s_add_u32 s7, s7, s9
    v_lshrrev_b32 v4, 1, v3
    v_and_b32 v5, 1, v3
    v_lshlrev_b32 v4, 9, v4
    v_lshl_add_u32 v4, v2, 4, v4
    v_lshl_add_u32 v4, v5, 3, v4
    buffer_store_dwordx2 v[116:117], v4, s[52:55], s7 offen
    s_endpgm
l1_kernel_e12:
    s_lshl_b32 s9, s8, 2
    s_add_u32 s9, s9, s3
    s_mul_i32 s9, s9, 640
    s_add_u32 s9, s9, s7
    s_add_u32 s9, s9, 5120
    v_bfe_u32 v4, v2, 2, 1
    v_mul_u32_u24 v4, 320, v4
    v_lshrrev_b32 v5, 3, v2
    v_and_b32 v6, 3, v2
    v_lshl_add_u32 v5, v5, 2, v6
    v_lshl_add_u32 v4, v5, 1, v4
    v_lshl_add_u32 v4, v3, 6, v4
    s_cmp_eq_u32 s5, 2
    s_cbranch_scc1 l1_kernel_ev
    s_lshl_b32 s8, s8, 3
    s_lshl_b32 s10, s3, 8
    s_add_u32 s7, s7, s8
    s_add_u32 s7, s7, s10
    s_add_u32 s7, s7, 4096
    v_lshlrev_b32 v5, 4, v2
    v_add_u32 v4, 64, v4
    s_mov_b32 exec_lo, 0xffff0000
    s_mov_b32 exec_hi, 0
    buffer_store_dwordx2 v[116:117], v5, s[52:55], s7 offen
    s_mov_b32 exec_lo, 0
    s_mov_b32 exec_hi, 0xffff0000
l1_kernel_ev:
    buffer_store_short v116, v4, s[52:55], s9 offen
    buffer_store_short_d16_hi v116, v4, s[52:55], s9 offen offset:16
    buffer_store_short v117, v4, s[52:55], s9 offen offset:32
    buffer_store_short_d16_hi v117, v4, s[52:55], s9 offen offset:48
    s_endpgm
l1_kernel_e3:
    s_lshl_b32 s7, s4, 6
    s_lshl_b32 s8, s3, 4
    s_add_u32 s7, s7, s8
    v_add_u32 v3, s7, v2
    v_lshlrev_b32 v4, 16, v116
    v_ashrrev_i32 v5, 31, v4
    v_or_b32 v5, 0x80000000, v5
    v_xor_b32 v4, v4, v5
    v_and_b32 v4, 0xffff0000, v4
    v_sub_u32 v5, 0xffff, v3
    v_or_b32 v4, v4, v5
    v_lshlrev_b32 v3, 2, v3
    s_mov_b32 s7, 8028160
    s_mov_b64 exec, 0xffff
    buffer_store_dword v4, v3, s[52:55], s7 offen
l1_kernel_end:
    s_endpgm
.globl l2_kernel
.p2align 8
.type l2_kernel,@function
l2_kernel:
    s_cmp_ge_u32 s2, 256
    s_cbranch_scc1 l2_kernel_end
    s_load_dwordx16 s[16:31], s[0:1], 0
    s_load_dwordx8 s[32:39], s[0:1], 64
    s_load_dwordx2 s[40:41], s[0:1], 96
    v_lshrrev_b32 v1, 6, v0
    v_and_b32 v0, 63, v0
    s_and_b32 s4, s2, 7
    v_readfirstlane_b32 s3, v1
    s_lshr_b32 s5, s2, 3
    s_lshl_b32 s4, s4, 2
    s_lshr_b32 s6, s5, 3
    s_add_u32 s4, s4, s6
    s_and_b32 s5, s5, 7
    s_cmp_eq_u32 s3, 8
    s_cbranch_scc1 l2_kernel_ffn
    v_lshlrev_b32 v10, 4, v0
    v_and_b32 v2, 31, v0
    v_lshrrev_b32 v3, 5, v0
    v_lshlrev_b32 v4, 3, v2
    v_bfe_u32 v5, v0, 4, 1
    v_and_b32 v6, 15, v0
    v_mul_u32_u24 v5, 20480, v5
    v_lshl_add_u32 v5, v3, 12, v5
    v_lshl_add_u32 v15, v6, 4, v5
    v_mul_u32_u24 v6, 20, v3
    v_add_u32 v6, v6, v2
    v_lshlrev_b32 v6, 4, v6
    v_add_u32 v11, 5120, v6
    s_lshl_b32 s9, s4, 3
    s_add_u32 s9, s9, s5
    s_lshl_b32 s9, s9, 3
    s_add_u32 s9, s9, s3
    s_mul_i32 s6, s9, 1280
    s_lshl_b32 s9, s4, 1
    s_and_b32 s10, s3, 1
    s_add_u32 s9, s9, s10
    s_mul_i32 s9, s9, 40960
    s_lshl_b32 s10, s5, 1
    s_lshr_b32 s11, s3, 2
    s_add_u32 s10, s10, s11
    s_lshl_b32 s10, s10, 8
    s_add_u32 s9, s9, s10
    s_and_b32 s10, s3, 2
    s_lshl_b32 s10, s10, 2
    s_add_u32 s9, s9, s10
    s_lshl_b32 s10, s3, 10
    s_add_u32 s11, s10, 7864320
    s_mov_b32 s60, 0x000fffff
    s_mov_b32 s61, 0x000fffff
    s_waitcnt lgkmcnt(0)
    s_mov_b32 s44, s40
    s_and_b32 s45, s41, 0xffff
    s_mov_b32 s46, 9437184
    s_mov_b32 s47, 0x00020000
    buffer_load_dwordx4 v[156:159], v10, s[44:47], s6 offen
    buffer_load_dwordx2 v[160:161], v4, s[44:47], s6 offen offset:1024
    s_add_u32 m0, s10, 0
    s_add_u32 s14, s11, 0
    buffer_load_dwordx4 v10, s[44:47], s14 offen lds
    s_add_u32 m0, s10, 8192
    s_add_u32 s14, s11, 8192
    buffer_load_dwordx4 v10, s[44:47], s14 offen lds
    s_add_u32 m0, s10, 16384
    s_add_u32 s14, s11, 16384
    buffer_load_dwordx4 v10, s[44:47], s14 offen lds
    v_mov_b32 v4, 0x3f803f80
    v_cmp_eq_u32 vcc, 20, v2
    s_add_u32 s9, s9, 2621440
    s_mov_b32 s12, 1
    s_mov_b32 s7, 18
    s_mov_b32 s13, 0
    v_cndmask_b32 v140, 0, v4, vcc
    v_cndmask_b32 v141, 0, v4, vcc
    v_cndmask_b32 v142, 0, v4, vcc
    v_cndmask_b32 v143, 0, v4, vcc
    v_cndmask_b32 v144, 0, v4, vcc
    v_cndmask_b32 v145, 0, v4, vcc
    v_cndmask_b32 v146, 0, v4, vcc
    v_cndmask_b32 v147, 0, v4, vcc
    v_cndmask_b32 v148, 0, v4, vcc
    v_cndmask_b32 v149, 0, v4, vcc
    v_cndmask_b32 v150, 0, v4, vcc
    v_cndmask_b32 v151, 0, v4, vcc
    v_cndmask_b32 v152, 0, v4, vcc
    v_cndmask_b32 v153, 0, v4, vcc
    v_cndmask_b32 v154, 0, v4, vcc
    v_cndmask_b32 v155, 0, v4, vcc
    s_cmp_lt_u32 s3, 4
    s_cbranch_scc1 l2_kernel_lowp
    s_setprio 1
    s_bitset1_b32 s7, 13
l2_kernel_lowp:
    v_mov_b32 v96, 0
    v_mov_b32 v97, 0
    v_mov_b32 v98, 0
    v_mov_b32 v99, 0
    v_mov_b32 v100, 0
    v_mov_b32 v101, 0
    v_mov_b32 v102, 0
    v_mov_b32 v103, 0
    v_mov_b32 v104, 0
    v_mov_b32 v105, 0
    v_mov_b32 v106, 0
    v_mov_b32 v107, 0
    v_mov_b32 v108, 0
    v_mov_b32 v109, 0
    v_mov_b32 v110, 0
    v_mov_b32 v111, 0
    v_mov_b32 v88, 0
    v_mov_b32 v89, 0
    v_mov_b32 v90, 0
    v_mov_b32 v91, 0
    s_mov_b32 s6, 0
    s_mov_b32 s8, 40960
    v_mov_b32 v13, v11
    v_mov_b32 v18, v10
    v_add_u32 v12, s8, v10
    v_add_u32 v14, s8, v11
    s_waitcnt vmcnt(0)
    s_barrier
    ds_read_b128 v[128:131], v10
    ds_read_b128 v[132:135], v10 offset:1024
    ds_read_b128 v[136:139], v10 offset:4096
    s_waitcnt lgkmcnt(2)
    v_mfma_f32_32x32x16_bf16 v[32:47], v[128:131], v[156:159], 0
    s_waitcnt lgkmcnt(1)
    v_mfma_f32_32x32x16_bf16 v[48:63], v[132:135], v[156:159], 0
    s_mov_b64 exec, s[60:61]
    ds_read_b128 v[140:143], v13
    s_mov_b64 exec, -1
    ds_read_b128 v[128:131], v10 offset:2048
    ds_read_b128 v[132:135], v10 offset:3072
    s_mov_b64 exec, s[60:61]
    ds_read_b128 v[144:147], v13 offset:640
    ds_read_b128 v[148:151], v13 offset:1280
    s_mov_b64 exec, -1
    s_waitcnt lgkmcnt(5)
    v_mfma_f32_32x32x4_2b_bf16 v[32:63], v[136:137], v[160:161], v[32:63]
    s_nop 7
    s_nop 7
    s_nop 3
    v_max_f32 v16, v32, v33
    v_max_f32 v17, v34, v35
    v_max3_f32 v16, v36, v37, v16
    v_max3_f32 v17, v38, v39, v17
    v_max3_f32 v16, v40, v41, v16
    v_max3_f32 v17, v42, v43, v17
    v_max3_f32 v16, v44, v45, v16
    v_max3_f32 v17, v46, v47, v17
    v_max3_f32 v16, v48, v49, v16
    v_max3_f32 v17, v50, v51, v17
    v_max3_f32 v16, v52, v53, v16
    v_max3_f32 v17, v54, v55, v17
    v_max3_f32 v16, v56, v57, v16
    v_max3_f32 v17, v58, v59, v17
    v_max3_f32 v16, v60, v61, v16
    v_max3_f32 v17, v62, v63, v17
    v_max_f32 v16, v16, v17
    v_max_f32 v17, v16, v17
    s_nop 1
    v_permlane32_swap_b32 v16, v17
    v_max_f32 v16, v16, v17
    v_xor_b32 v112, 0x80000000, v16
    v_xor_b32 v113, 0x80000000, v16
    v_xor_b32 v114, 0x80000000, v16
    v_xor_b32 v115, 0x80000000, v16
    v_xor_b32 v116, 0x80000000, v16
    v_xor_b32 v117, 0x80000000, v16
    v_xor_b32 v118, 0x80000000, v16
    v_xor_b32 v119, 0x80000000, v16
    v_xor_b32 v120, 0x80000000, v16
    v_xor_b32 v121, 0x80000000, v16
    v_xor_b32 v122, 0x80000000, v16
    v_xor_b32 v123, 0x80000000, v16
    v_xor_b32 v124, 0x80000000, v16
    v_xor_b32 v125, 0x80000000, v16
    v_xor_b32 v126, 0x80000000, v16
    v_xor_b32 v127, 0x80000000, v16
    v_pk_add_f32 v[32:33], v[32:33], v[112:113]
    v_pk_add_f32 v[34:35], v[34:35], v[112:113]
    v_pk_add_f32 v[36:37], v[36:37], v[112:113]
    v_pk_add_f32 v[38:39], v[38:39], v[112:113]
    v_pk_add_f32 v[40:41], v[40:41], v[112:113]
    v_pk_add_f32 v[42:43], v[42:43], v[112:113]
    v_pk_add_f32 v[44:45], v[44:45], v[112:113]
    v_pk_add_f32 v[46:47], v[46:47], v[112:113]
    v_pk_add_f32 v[48:49], v[48:49], v[112:113]
    v_pk_add_f32 v[50:51], v[50:51], v[112:113]
    v_pk_add_f32 v[52:53], v[52:53], v[112:113]
    v_pk_add_f32 v[54:55], v[54:55], v[112:113]
    v_pk_add_f32 v[56:57], v[56:57], v[112:113]
    v_pk_add_f32 v[58:59], v[58:59], v[112:113]
    v_pk_add_f32 v[60:61], v[60:61], v[112:113]
    v_pk_add_f32 v[62:63], v[62:63], v[112:113]
l2_kernel_join:
l2_kernel_loop:
    s_bitcmp1_b32 s7, s6
    s_cbranch_scc1 l2_kernel_stub0
l2_kernel_back0:
    v_exp_f32 v32, v32
    v_exp_f32 v33, v33
    s_waitcnt lgkmcnt(2)
    v_mfma_f32_32x32x16_bf16 v[96:111], v[152:155], v[88:91], v[96:111]
    s_mov_b64 exec, s[60:61]
    ds_read_b128 v[148:151], v13 offset:1280
    ds_read_b128 v[152:155], v13 offset:1920
    s_mov_b64 exec, -1
    v_exp_f32 v34, v34
    v_cvt_pk_bf16_f32 v32, v32, v33
    v_exp_f32 v35, v35
    v_exp_f32 v36, v36
    v_cvt_pk_bf16_f32 v33, v34, v35
    v_exp_f32 v37, v37
    v_mfma_f32_32x32x16_bf16 v[64:79], v[128:131], v[156:159], v[112:127]
    v_exp_f32 v38, v38
    v_cvt_pk_bf16_f32 v34, v36, v37
    v_exp_f32 v39, v39
    v_exp_f32 v40, v40
    v_cvt_pk_bf16_f32 v35, v38, v39
    v_exp_f32 v41, v41
    v_mfma_f32_32x32x16_bf16 v[80:95], v[132:135], v[156:159], v[112:127]
    v_exp_f32 v42, v42
    v_cvt_pk_bf16_f32 v40, v40, v41
    v_exp_f32 v43, v43
    v_exp_f32 v44, v44
    v_cvt_pk_bf16_f32 v41, v42, v43
    v_exp_f32 v45, v45
    s_waitcnt lgkmcnt(1)
    v_mfma_f32_32x32x16_bf16 v[96:111], v[140:143], v[32:35], v[96:111]
    v_exp_f32 v46, v46
    v_cvt_pk_bf16_f32 v42, v44, v45
    v_exp_f32 v47, v47
    v_exp_f32 v48, v48
    v_cvt_pk_bf16_f32 v43, v46, v47
    v_exp_f32 v49, v49
    v_mfma_f32_32x32x4_2b_bf16 v[64:95], v[138:139], v[160:161], v[64:95]
    ds_read_b128 v[128:131], v18 offset:10240
    ds_read_b128 v[132:135], v18 offset:11264
    ds_read_b128 v[136:139], v18 offset:14336
    v_exp_f32 v50, v50
    v_cvt_pk_bf16_f32 v48, v48, v49
    v_exp_f32 v51, v51
    v_exp_f32 v52, v52
    v_cvt_pk_bf16_f32 v49, v50, v51
    v_exp_f32 v53, v53
    v_exp_f32 v54, v54
    v_cvt_pk_bf16_f32 v50, v52, v53
    v_mfma_f32_32x32x16_bf16 v[96:111], v[144:147], v[40:43], v[96:111]
    s_mov_b64 exec, s[60:61]
    ds_read_b128 v[140:143], v13 offset:2560
    ds_read_b128 v[144:147], v13 offset:3200
    s_mov_b64 exec, -1
    v_exp_f32 v55, v55
    v_exp_f32 v56, v56
    v_cvt_pk_bf16_f32 v51, v54, v55
    v_exp_f32 v57, v57
    v_exp_f32 v58, v58
    v_cvt_pk_bf16_f32 v56, v56, v57
    v_exp_f32 v59, v59
    v_mfma_f32_32x32x16_bf16 v[96:111], v[148:151], v[48:51], v[96:111]
    v_exp_f32 v60, v60
    v_cvt_pk_bf16_f32 v57, v58, v59
    v_exp_f32 v61, v61
    v_exp_f32 v62, v62
    v_cvt_pk_bf16_f32 v58, v60, v61
    v_exp_f32 v63, v63
    s_nop 0
    v_cvt_pk_bf16_f32 v59, v62, v63
    v_exp_f32 v64, v64
    v_exp_f32 v65, v65
    s_waitcnt lgkmcnt(3)
    v_mfma_f32_32x32x16_bf16 v[96:111], v[152:155], v[56:59], v[96:111]
    s_mov_b64 exec, s[60:61]
    ds_read_b128 v[148:151], v13 offset:3840
    ds_read_b128 v[152:155], v13 offset:4480
    s_mov_b64 exec, -1
    v_exp_f32 v66, v66
    v_cvt_pk_bf16_f32 v64, v64, v65
    v_exp_f32 v67, v67
    v_exp_f32 v68, v68
    v_cvt_pk_bf16_f32 v65, v66, v67
    v_exp_f32 v69, v69
    v_mfma_f32_32x32x16_bf16 v[32:47], v[128:131], v[156:159], v[112:127]
    v_exp_f32 v70, v70
    v_cvt_pk_bf16_f32 v66, v68, v69
    v_exp_f32 v71, v71
    v_exp_f32 v72, v72
    v_cvt_pk_bf16_f32 v67, v70, v71
    v_exp_f32 v73, v73
    v_mfma_f32_32x32x16_bf16 v[48:63], v[132:135], v[156:159], v[112:127]
    v_exp_f32 v74, v74
    v_cvt_pk_bf16_f32 v72, v72, v73
    v_exp_f32 v75, v75
    v_exp_f32 v76, v76
    v_cvt_pk_bf16_f32 v73, v74, v75
    v_exp_f32 v77, v77
    s_waitcnt lgkmcnt(1)
    v_mfma_f32_32x32x16_bf16 v[96:111], v[140:143], v[64:67], v[96:111]
    v_exp_f32 v78, v78
    v_cvt_pk_bf16_f32 v74, v76, v77
    v_exp_f32 v79, v79
    v_exp_f32 v80, v80
    v_cvt_pk_bf16_f32 v75, v78, v79
    v_exp_f32 v81, v81
    v_mfma_f32_32x32x4_2b_bf16 v[32:63], v[136:137], v[160:161], v[32:63]
    ds_read_b128 v[128:131], v18 offset:12288
    ds_read_b128 v[132:135], v18 offset:13312
    v_exp_f32 v82, v82
    v_cvt_pk_bf16_f32 v80, v80, v81
    v_exp_f32 v83, v83
    v_exp_f32 v84, v84
    v_cvt_pk_bf16_f32 v81, v82, v83
    v_exp_f32 v85, v85
    v_exp_f32 v86, v86
    v_cvt_pk_bf16_f32 v82, v84, v85
    v_mfma_f32_32x32x16_bf16 v[96:111], v[144:147], v[72:75], v[96:111]
    s_mov_b64 exec, s[60:61]
    ds_read_b128 v[140:143], v13 offset:10240
    ds_read_b128 v[144:147], v13 offset:10880
    s_mov_b64 exec, -1
    v_exp_f32 v87, v87
    v_exp_f32 v88, v88
    v_cvt_pk_bf16_f32 v83, v86, v87
    v_exp_f32 v89, v89
    v_exp_f32 v90, v90
    v_cvt_pk_bf16_f32 v88, v88, v89
    v_exp_f32 v91, v91
    v_mfma_f32_32x32x16_bf16 v[96:111], v[148:151], v[80:83], v[96:111]
    v_exp_f32 v92, v92
    v_cvt_pk_bf16_f32 v89, v90, v91
    v_exp_f32 v93, v93
    v_exp_f32 v94, v94
    v_cvt_pk_bf16_f32 v90, v92, v93
    v_exp_f32 v95, v95
    s_add_u32 s6, s6, 1
    v_cvt_pk_bf16_f32 v91, v94, v95
    s_bitcmp1_b32 s7, s6
    s_cbranch_scc1 l2_kernel_stub1
l2_kernel_back1:
    v_exp_f32 v32, v32
    v_exp_f32 v33, v33
    s_waitcnt lgkmcnt(2)
    v_mfma_f32_32x32x16_bf16 v[96:111], v[152:155], v[88:91], v[96:111]
    s_mov_b64 exec, s[60:61]
    ds_read_b128 v[148:151], v13 offset:11520
    ds_read_b128 v[152:155], v13 offset:12160
    s_mov_b64 exec, -1
    v_exp_f32 v34, v34
    v_cvt_pk_bf16_f32 v32, v32, v33
    v_exp_f32 v35, v35
    v_exp_f32 v36, v36
    v_cvt_pk_bf16_f32 v33, v34, v35
    v_exp_f32 v37, v37
    v_mfma_f32_32x32x16_bf16 v[64:79], v[128:131], v[156:159], v[112:127]
    v_exp_f32 v38, v38
    v_cvt_pk_bf16_f32 v34, v36, v37
    v_exp_f32 v39, v39
    v_exp_f32 v40, v40
    v_cvt_pk_bf16_f32 v35, v38, v39
    v_exp_f32 v41, v41
    v_mfma_f32_32x32x16_bf16 v[80:95], v[132:135], v[156:159], v[112:127]
    v_exp_f32 v42, v42
    v_cvt_pk_bf16_f32 v40, v40, v41
    v_exp_f32 v43, v43
    v_exp_f32 v44, v44
    v_cvt_pk_bf16_f32 v41, v42, v43
    v_exp_f32 v45, v45
    s_waitcnt lgkmcnt(1)
    v_mfma_f32_32x32x16_bf16 v[96:111], v[140:143], v[32:35], v[96:111]
    v_exp_f32 v46, v46
    v_cvt_pk_bf16_f32 v42, v44, v45
    v_exp_f32 v47, v47
    v_exp_f32 v48, v48
    v_cvt_pk_bf16_f32 v43, v46, v47
    v_exp_f32 v49, v49
    v_mfma_f32_32x32x4_2b_bf16 v[64:95], v[138:139], v[160:161], v[64:95]
    ds_read_b128 v[128:131], v18 offset:20480
    ds_read_b128 v[132:135], v18 offset:21504
    ds_read_b128 v[136:139], v18 offset:24576
    v_exp_f32 v50, v50
    v_cvt_pk_bf16_f32 v48, v48, v49
    v_exp_f32 v51, v51
    v_exp_f32 v52, v52
    v_cvt_pk_bf16_f32 v49, v50, v51
    v_exp_f32 v53, v53
    v_exp_f32 v54, v54
    v_cvt_pk_bf16_f32 v50, v52, v53
    v_mfma_f32_32x32x16_bf16 v[96:111], v[144:147], v[40:43], v[96:111]
    s_mov_b64 exec, s[60:61]
    ds_read_b128 v[140:143], v13 offset:12800
    ds_read_b128 v[144:147], v13 offset:13440
    s_mov_b64 exec, -1
    v_exp_f32 v55, v55
    v_exp_f32 v56, v56
    v_cvt_pk_bf16_f32 v51, v54, v55
    v_exp_f32 v57, v57
    v_exp_f32 v58, v58
    v_cvt_pk_bf16_f32 v56, v56, v57
    v_exp_f32 v59, v59
    v_mfma_f32_32x32x16_bf16 v[96:111], v[148:151], v[48:51], v[96:111]
    v_exp_f32 v60, v60
    v_cvt_pk_bf16_f32 v57, v58, v59
    v_exp_f32 v61, v61
    v_exp_f32 v62, v62
    v_cvt_pk_bf16_f32 v58, v60, v61
    v_exp_f32 v63, v63
    s_nop 0
    v_cvt_pk_bf16_f32 v59, v62, v63
    v_exp_f32 v64, v64
    v_exp_f32 v65, v65
    s_waitcnt lgkmcnt(3)
    v_mfma_f32_32x32x16_bf16 v[96:111], v[152:155], v[56:59], v[96:111]
    s_mov_b64 exec, s[60:61]
    ds_read_b128 v[148:151], v13 offset:14080
    ds_read_b128 v[152:155], v13 offset:14720
    s_mov_b64 exec, -1
    v_exp_f32 v66, v66
    v_cvt_pk_bf16_f32 v64, v64, v65
    v_exp_f32 v67, v67
    v_exp_f32 v68, v68
    v_cvt_pk_bf16_f32 v65, v66, v67
    v_exp_f32 v69, v69
    v_mfma_f32_32x32x16_bf16 v[32:47], v[128:131], v[156:159], v[112:127]
    v_exp_f32 v70, v70
    v_cvt_pk_bf16_f32 v66, v68, v69
    v_exp_f32 v71, v71
    v_exp_f32 v72, v72
    v_cvt_pk_bf16_f32 v67, v70, v71
    v_exp_f32 v73, v73
    v_mfma_f32_32x32x16_bf16 v[48:63], v[132:135], v[156:159], v[112:127]
    v_exp_f32 v74, v74
    v_cvt_pk_bf16_f32 v72, v72, v73
    v_exp_f32 v75, v75
    v_exp_f32 v76, v76
    v_cvt_pk_bf16_f32 v73, v74, v75
    v_exp_f32 v77, v77
    s_waitcnt lgkmcnt(1)
    v_mfma_f32_32x32x16_bf16 v[96:111], v[140:143], v[64:67], v[96:111]
    v_exp_f32 v78, v78
    v_cvt_pk_bf16_f32 v74, v76, v77
    v_exp_f32 v79, v79
    v_exp_f32 v80, v80
    v_cvt_pk_bf16_f32 v75, v78, v79
    v_exp_f32 v81, v81
    v_mfma_f32_32x32x4_2b_bf16 v[32:63], v[136:137], v[160:161], v[32:63]
    ds_read_b128 v[128:131], v18 offset:22528
    ds_read_b128 v[132:135], v18 offset:23552
    v_exp_f32 v82, v82
    v_cvt_pk_bf16_f32 v80, v80, v81
    v_exp_f32 v83, v83
    v_exp_f32 v84, v84
    v_cvt_pk_bf16_f32 v81, v82, v83
    v_exp_f32 v85, v85
    v_exp_f32 v86, v86
    v_cvt_pk_bf16_f32 v82, v84, v85
    v_mfma_f32_32x32x16_bf16 v[96:111], v[144:147], v[72:75], v[96:111]
    s_mov_b64 exec, s[60:61]
    ds_read_b128 v[140:143], v13 offset:20480
    ds_read_b128 v[144:147], v13 offset:21120
    s_mov_b64 exec, -1
    v_exp_f32 v87, v87
    v_exp_f32 v88, v88
    v_cvt_pk_bf16_f32 v83, v86, v87
    v_exp_f32 v89, v89
    v_exp_f32 v90, v90
    v_cvt_pk_bf16_f32 v88, v88, v89
    v_exp_f32 v91, v91
    v_mfma_f32_32x32x16_bf16 v[96:111], v[148:151], v[80:83], v[96:111]
    v_exp_f32 v92, v92
    v_cvt_pk_bf16_f32 v89, v90, v91
    v_exp_f32 v93, v93
    v_exp_f32 v94, v94
    v_cvt_pk_bf16_f32 v90, v92, v93
    v_exp_f32 v95, v95
    s_add_u32 s6, s6, 1
    v_cvt_pk_bf16_f32 v91, v94, v95
    v_exp_f32 v32, v32
    v_exp_f32 v33, v33
    s_waitcnt lgkmcnt(2)
    v_mfma_f32_32x32x16_bf16 v[96:111], v[152:155], v[88:91], v[96:111]
    s_mov_b64 exec, s[60:61]
    ds_read_b128 v[148:151], v13 offset:21760
    ds_read_b128 v[152:155], v13 offset:22400
    s_mov_b64 exec, -1
    v_exp_f32 v34, v34
    v_cvt_pk_bf16_f32 v32, v32, v33
    v_exp_f32 v35, v35
    v_exp_f32 v36, v36
    v_cvt_pk_bf16_f32 v33, v34, v35
    v_exp_f32 v37, v37
    v_mfma_f32_32x32x16_bf16 v[64:79], v[128:131], v[156:159], v[112:127]
    v_exp_f32 v38, v38
    v_cvt_pk_bf16_f32 v34, v36, v37
    v_exp_f32 v39, v39
    v_exp_f32 v40, v40
    v_cvt_pk_bf16_f32 v35, v38, v39
    v_exp_f32 v41, v41
    v_mfma_f32_32x32x16_bf16 v[80:95], v[132:135], v[156:159], v[112:127]
    v_exp_f32 v42, v42
    v_cvt_pk_bf16_f32 v40, v40, v41
    v_exp_f32 v43, v43
    v_exp_f32 v44, v44
    v_cvt_pk_bf16_f32 v41, v42, v43
    v_exp_f32 v45, v45
    s_waitcnt lgkmcnt(1)
    v_mfma_f32_32x32x16_bf16 v[96:111], v[140:143], v[32:35], v[96:111]
    v_exp_f32 v46, v46
    v_cvt_pk_bf16_f32 v42, v44, v45
    v_exp_f32 v47, v47
    v_exp_f32 v48, v48
    v_cvt_pk_bf16_f32 v43, v46, v47
    v_exp_f32 v49, v49
    v_mfma_f32_32x32x4_2b_bf16 v[64:95], v[138:139], v[160:161], v[64:95]
    ds_read_b128 v[128:131], v18 offset:30720
    ds_read_b128 v[132:135], v18 offset:31744
    ds_read_b128 v[136:139], v18 offset:34816
    v_exp_f32 v50, v50
    v_cvt_pk_bf16_f32 v48, v48, v49
    v_exp_f32 v51, v51
    v_exp_f32 v52, v52
    v_cvt_pk_bf16_f32 v49, v50, v51
    v_exp_f32 v53, v53
    v_exp_f32 v54, v54
    v_cvt_pk_bf16_f32 v50, v52, v53
    v_mfma_f32_32x32x16_bf16 v[96:111], v[144:147], v[40:43], v[96:111]
    s_mov_b64 exec, s[60:61]
    ds_read_b128 v[140:143], v13 offset:23040
    ds_read_b128 v[144:147], v13 offset:23680
    s_mov_b64 exec, -1
    v_exp_f32 v55, v55
    v_exp_f32 v56, v56
    v_cvt_pk_bf16_f32 v51, v54, v55
    v_exp_f32 v57, v57
    v_exp_f32 v58, v58
    v_cvt_pk_bf16_f32 v56, v56, v57
    v_exp_f32 v59, v59
    v_mfma_f32_32x32x16_bf16 v[96:111], v[148:151], v[48:51], v[96:111]
    v_exp_f32 v60, v60
    v_cvt_pk_bf16_f32 v57, v58, v59
    v_exp_f32 v61, v61
    v_exp_f32 v62, v62
    v_cvt_pk_bf16_f32 v58, v60, v61
    v_exp_f32 v63, v63
    s_nop 0
    v_cvt_pk_bf16_f32 v59, v62, v63
    v_exp_f32 v64, v64
    v_exp_f32 v65, v65
    s_waitcnt lgkmcnt(3)
    v_mfma_f32_32x32x16_bf16 v[96:111], v[152:155], v[56:59], v[96:111]
    s_mov_b64 exec, s[60:61]
    ds_read_b128 v[148:151], v13 offset:24320
    ds_read_b128 v[152:155], v13 offset:24960
    s_mov_b64 exec, -1
    v_exp_f32 v66, v66
    v_cvt_pk_bf16_f32 v64, v64, v65
    v_exp_f32 v67, v67
    v_exp_f32 v68, v68
    v_cvt_pk_bf16_f32 v65, v66, v67
    v_exp_f32 v69, v69
    v_mfma_f32_32x32x16_bf16 v[32:47], v[128:131], v[156:159], v[112:127]
    v_exp_f32 v70, v70
    v_cvt_pk_bf16_f32 v66, v68, v69
    v_exp_f32 v71, v71
    v_exp_f32 v72, v72
    v_cvt_pk_bf16_f32 v67, v70, v71
    v_exp_f32 v73, v73
    v_mfma_f32_32x32x16_bf16 v[48:63], v[132:135], v[156:159], v[112:127]
    v_exp_f32 v74, v74
    v_cvt_pk_bf16_f32 v72, v72, v73
    v_exp_f32 v75, v75
    v_exp_f32 v76, v76
    v_cvt_pk_bf16_f32 v73, v74, v75
    v_exp_f32 v77, v77
    s_waitcnt lgkmcnt(1)
    v_mfma_f32_32x32x16_bf16 v[96:111], v[140:143], v[64:67], v[96:111]
    v_exp_f32 v78, v78
    v_cvt_pk_bf16_f32 v74, v76, v77
    v_exp_f32 v79, v79
    v_exp_f32 v80, v80
    v_cvt_pk_bf16_f32 v75, v78, v79
    v_exp_f32 v81, v81
    v_mfma_f32_32x32x4_2b_bf16 v[32:63], v[136:137], v[160:161], v[32:63]
    ds_read_b128 v[128:131], v18 offset:32768
    ds_read_b128 v[132:135], v18 offset:33792
    v_exp_f32 v82, v82
    v_cvt_pk_bf16_f32 v80, v80, v81
    v_exp_f32 v83, v83
    v_exp_f32 v84, v84
    v_cvt_pk_bf16_f32 v81, v82, v83
    v_exp_f32 v85, v85
    v_exp_f32 v86, v86
    v_cvt_pk_bf16_f32 v82, v84, v85
    v_mfma_f32_32x32x16_bf16 v[96:111], v[144:147], v[72:75], v[96:111]
    s_mov_b64 exec, s[60:61]
    ds_read_b128 v[140:143], v13 offset:30720
    ds_read_b128 v[144:147], v13 offset:31360
    s_mov_b64 exec, -1
    v_exp_f32 v87, v87
    v_exp_f32 v88, v88
    v_cvt_pk_bf16_f32 v83, v86, v87
    v_exp_f32 v89, v89
    v_exp_f32 v90, v90
    v_cvt_pk_bf16_f32 v88, v88, v89
    v_exp_f32 v91, v91
    v_mfma_f32_32x32x16_bf16 v[96:111], v[148:151], v[80:83], v[96:111]
    v_exp_f32 v92, v92
    v_cvt_pk_bf16_f32 v89, v90, v91
    v_exp_f32 v93, v93
    v_exp_f32 v94, v94
    v_cvt_pk_bf16_f32 v90, v92, v93
    v_exp_f32 v95, v95
    s_add_u32 s6, s6, 1
    v_cvt_pk_bf16_f32 v91, v94, v95
    v_exp_f32 v32, v32
    v_exp_f32 v33, v33
    s_waitcnt lgkmcnt(2)
    v_mfma_f32_32x32x16_bf16 v[96:111], v[152:155], v[88:91], v[96:111]
    s_mov_b64 exec, s[60:61]
    ds_read_b128 v[148:151], v13 offset:32000
    ds_read_b128 v[152:155], v13 offset:32640
    s_mov_b64 exec, -1
    v_exp_f32 v34, v34
    v_cvt_pk_bf16_f32 v32, v32, v33
    v_exp_f32 v35, v35
    v_exp_f32 v36, v36
    v_cvt_pk_bf16_f32 v33, v34, v35
    v_exp_f32 v37, v37
    v_mfma_f32_32x32x16_bf16 v[64:79], v[128:131], v[156:159], v[112:127]
    v_exp_f32 v38, v38
    v_cvt_pk_bf16_f32 v34, v36, v37
    v_exp_f32 v39, v39
    v_exp_f32 v40, v40
    v_cvt_pk_bf16_f32 v35, v38, v39
    v_exp_f32 v41, v41
    v_mfma_f32_32x32x16_bf16 v[80:95], v[132:135], v[156:159], v[112:127]
    v_exp_f32 v42, v42
    v_cvt_pk_bf16_f32 v40, v40, v41
    v_exp_f32 v43, v43
    v_exp_f32 v44, v44
    v_cvt_pk_bf16_f32 v41, v42, v43
    v_exp_f32 v45, v45
    s_waitcnt lgkmcnt(1)
    v_mfma_f32_32x32x16_bf16 v[96:111], v[140:143], v[32:35], v[96:111]
    v_exp_f32 v46, v46
    v_cvt_pk_bf16_f32 v42, v44, v45
    v_exp_f32 v47, v47
    v_exp_f32 v48, v48
    v_cvt_pk_bf16_f32 v43, v46, v47
    v_exp_f32 v49, v49
    v_mfma_f32_32x32x4_2b_bf16 v[64:95], v[138:139], v[160:161], v[64:95]
    ds_read_b128 v[128:131], v12 offset:0
    ds_read_b128 v[132:135], v12 offset:1024
    ds_read_b128 v[136:139], v12 offset:4096
    v_exp_f32 v50, v50
    v_cvt_pk_bf16_f32 v48, v48, v49
    v_exp_f32 v51, v51
    v_exp_f32 v52, v52
    v_cvt_pk_bf16_f32 v49, v50, v51
    v_exp_f32 v53, v53
    v_exp_f32 v54, v54
    v_cvt_pk_bf16_f32 v50, v52, v53
    v_mfma_f32_32x32x16_bf16 v[96:111], v[144:147], v[40:43], v[96:111]
    s_mov_b64 exec, s[60:61]
    ds_read_b128 v[140:143], v13 offset:33280
    ds_read_b128 v[144:147], v13 offset:33920
    s_mov_b64 exec, -1
    v_exp_f32 v55, v55
    v_exp_f32 v56, v56
    v_cvt_pk_bf16_f32 v51, v54, v55
    v_exp_f32 v57, v57
    v_exp_f32 v58, v58
    v_cvt_pk_bf16_f32 v56, v56, v57
    v_exp_f32 v59, v59
    v_mfma_f32_32x32x16_bf16 v[96:111], v[148:151], v[48:51], v[96:111]
    v_exp_f32 v60, v60
    v_cvt_pk_bf16_f32 v57, v58, v59
    v_exp_f32 v61, v61
    v_exp_f32 v62, v62
    v_cvt_pk_bf16_f32 v58, v60, v61
    v_exp_f32 v63, v63
    s_nop 0
    v_cvt_pk_bf16_f32 v59, v62, v63
    v_exp_f32 v64, v64
    v_exp_f32 v65, v65
    s_waitcnt lgkmcnt(3)
    v_mfma_f32_32x32x16_bf16 v[96:111], v[152:155], v[56:59], v[96:111]
    s_mov_b64 exec, s[60:61]
    ds_read_b128 v[148:151], v13 offset:34560
    ds_read_b128 v[152:155], v13 offset:35200
    s_mov_b64 exec, -1
    v_exp_f32 v66, v66
    v_cvt_pk_bf16_f32 v64, v64, v65
    v_exp_f32 v67, v67
    v_exp_f32 v68, v68
    v_cvt_pk_bf16_f32 v65, v66, v67
    v_exp_f32 v69, v69
    v_mfma_f32_32x32x16_bf16 v[32:47], v[128:131], v[156:159], v[112:127]
    v_exp_f32 v70, v70
    v_cvt_pk_bf16_f32 v66, v68, v69
    v_exp_f32 v71, v71
    v_exp_f32 v72, v72
    v_cvt_pk_bf16_f32 v67, v70, v71
    v_exp_f32 v73, v73
    v_mfma_f32_32x32x16_bf16 v[48:63], v[132:135], v[156:159], v[112:127]
    v_exp_f32 v74, v74
    v_cvt_pk_bf16_f32 v72, v72, v73
    v_exp_f32 v75, v75
    v_exp_f32 v76, v76
    v_cvt_pk_bf16_f32 v73, v74, v75
    v_exp_f32 v77, v77
    s_waitcnt lgkmcnt(1)
    v_mfma_f32_32x32x16_bf16 v[96:111], v[140:143], v[64:67], v[96:111]
    v_exp_f32 v78, v78
    v_cvt_pk_bf16_f32 v74, v76, v77
    v_exp_f32 v79, v79
    v_exp_f32 v80, v80
    v_cvt_pk_bf16_f32 v75, v78, v79
    v_exp_f32 v81, v81
    v_mfma_f32_32x32x4_2b_bf16 v[32:63], v[136:137], v[160:161], v[32:63]
    ds_read_b128 v[128:131], v12 offset:2048
    ds_read_b128 v[132:135], v12 offset:3072
    v_exp_f32 v82, v82
    v_cvt_pk_bf16_f32 v80, v80, v81
    v_exp_f32 v83, v83
    v_exp_f32 v84, v84
    v_cvt_pk_bf16_f32 v81, v82, v83
    v_exp_f32 v85, v85
    v_exp_f32 v86, v86
    v_cvt_pk_bf16_f32 v82, v84, v85
    v_mfma_f32_32x32x16_bf16 v[96:111], v[144:147], v[72:75], v[96:111]
    s_mov_b64 exec, s[60:61]
    ds_read_b128 v[140:143], v14 offset:0
    ds_read_b128 v[144:147], v14 offset:640
    s_mov_b64 exec, -1
    v_exp_f32 v87, v87
    v_exp_f32 v88, v88
    v_cvt_pk_bf16_f32 v83, v86, v87
    v_exp_f32 v89, v89
    v_exp_f32 v90, v90
    v_cvt_pk_bf16_f32 v88, v88, v89
    v_exp_f32 v91, v91
    v_mfma_f32_32x32x16_bf16 v[96:111], v[148:151], v[80:83], v[96:111]
    v_exp_f32 v92, v92
    v_cvt_pk_bf16_f32 v89, v90, v91
    v_exp_f32 v93, v93
    v_exp_f32 v94, v94
    v_cvt_pk_bf16_f32 v90, v92, v93
    v_exp_f32 v95, v95
    v_mov_b32 v13, v14
    v_mov_b32 v18, v12
    s_add_u32 s6, s6, 1
    s_add_u32 s8, s8, 40960
    s_cmp_ge_u32 s8, 163840
    s_cselect_b32 s8, 0, s8
    v_cvt_pk_bf16_f32 v91, v94, v95
    v_add_u32 v12, s8, v10
    v_add_u32 v14, s8, v11
    s_cmp_lt_u32 s6, 16
    s_cbranch_scc1 l2_kernel_loop
    s_waitcnt lgkmcnt(0)
    v_mfma_f32_32x32x16_bf16 v[96:111], v[152:155], v[88:91], v[96:111]
    s_nop 7
    s_nop 3
    v_mov_b32 v2, v104
    v_mov_b32 v3, v104
    v_add_f32 v4, |v96|, |v97|
    v_add_f32 v5, |v98|, |v99|
    v_permlane32_swap_b32 v2, v3
    v_add_f32 v4, v4, |v100|
    v_add_f32 v5, v5, |v101|
    v_add_f32 v4, v4, |v102|
    v_add_f32 v5, v5, |v103|
    v_add_f32 v4, v4, |v104|
    v_add_f32 v5, v5, |v105|
    v_add_f32 v4, v4, |v106|
    v_add_f32 v5, v5, |v107|
    v_rcp_f32 v3, v3
    v_add_f32 v4, v4, v5
    v_cmp_gt_f32 vcc, 0x71800000, v4
    s_cmp_lg_u32 s13, 0
    s_cbranch_scc1 l2_kernel_store
    s_cmp_eq_u64 vcc, exec
    s_cbranch_scc1 l2_kernel_store
    s_mov_b32 s13, 1
    s_mov_b32 s7, 0
    s_mov_b32 s12, 16
    s_branch l2_kernel_restart
l2_kernel_store:
    v_mul_f32 v96, v96, v3
    v_mul_f32 v97, v97, v3
    v_mul_f32 v98, v98, v3
    v_mul_f32 v99, v99, v3
    v_mul_f32 v100, v100, v3
    v_mul_f32 v101, v101, v3
    v_mul_f32 v102, v102, v3
    v_mul_f32 v103, v103, v3
    v_mul_f32 v104, v104, v3
    v_mul_f32 v105, v105, v3
    v_mul_f32 v106, v106, v3
    v_mul_f32 v107, v107, v3
    v_cvt_pk_bf16_f32 v96, v96, v97
    v_cvt_pk_bf16_f32 v97, v98, v99
    v_cvt_pk_bf16_f32 v98, v100, v101
    v_cvt_pk_bf16_f32 v99, v102, v103
    v_cvt_pk_bf16_f32 v100, v104, v105
    v_cvt_pk_bf16_f32 v101, v106, v107
    buffer_store_dwordx2 v[96:97], v15, s[44:47], s9 offen
    s_add_u32 s10, s9, 8192
    s_add_u32 s11, s9, 16384
    buffer_store_dwordx2 v[98:99], v15, s[44:47], s10 offen
    s_mov_b64 exec, 0xffffffff
    buffer_store_dwordx2 v[100:101], v15, s[44:47], s11 offen
    s_endpgm
l2_kernel_restart:
    v_mov_b32 v16, 0xff800000
    v_mov_b32 v17, v10
l2_kernel_ml:
    ds_read_b128 v[128:131], v17
    ds_read_b128 v[132:135], v17 offset:1024
    ds_read_b128 v[2:5], v17 offset:2048
    ds_read_b128 v[6:9], v17 offset:3072
    ds_read_b128 v[136:139], v17 offset:4096
    v_add_u32 v17, 10240, v17
    s_sub_u32 s12, s12, 1
    s_waitcnt lgkmcnt(4)
    v_mfma_f32_32x32x16_bf16 v[32:47], v[128:131], v[156:159], 0
    s_waitcnt lgkmcnt(3)
    v_mfma_f32_32x32x16_bf16 v[48:63], v[132:135], v[156:159], 0
    s_waitcnt lgkmcnt(2)
    v_mfma_f32_32x32x16_bf16 v[64:79], v[2:5], v[156:159], 0
    s_waitcnt lgkmcnt(1)
    v_mfma_f32_32x32x16_bf16 v[80:95], v[6:9], v[156:159], 0
    s_waitcnt lgkmcnt(0)
    s_nop 5
    v_mfma_f32_32x32x4_2b_bf16 v[32:63], v[136:137], v[160:161], v[32:63]
    s_nop 1
    v_mfma_f32_32x32x4_2b_bf16 v[64:95], v[138:139], v[160:161], v[64:95]
    s_nop 7
    s_nop 7
    s_nop 1
    v_max3_f32 v16, v32, v33, v16
    v_max3_f32 v16, v34, v35, v16
    v_max3_f32 v16, v36, v37, v16
    v_max3_f32 v16, v38, v39, v16
    v_max3_f32 v16, v40, v41, v16
    v_max3_f32 v16, v42, v43, v16
    v_max3_f32 v16, v44, v45, v16
    v_max3_f32 v16, v46, v47, v16
    v_max3_f32 v16, v48, v49, v16
    v_max3_f32 v16, v50, v51, v16
    v_max3_f32 v16, v52, v53, v16
    v_max3_f32 v16, v54, v55, v16
    v_max3_f32 v16, v56, v57, v16
    v_max3_f32 v16, v58, v59, v16
    v_max3_f32 v16, v60, v61, v16
    v_max3_f32 v16, v62, v63, v16
    s_nop 3
    v_max3_f32 v16, v64, v65, v16
    v_max3_f32 v16, v66, v67, v16
    v_max3_f32 v16, v68, v69, v16
    v_max3_f32 v16, v70, v71, v16
    v_max3_f32 v16, v72, v73, v16
    v_max3_f32 v16, v74, v75, v16
    v_max3_f32 v16, v76, v77, v16
    v_max3_f32 v16, v78, v79, v16
    v_max3_f32 v16, v80, v81, v16
    v_max3_f32 v16, v82, v83, v16
    v_max3_f32 v16, v84, v85, v16
    v_max3_f32 v16, v86, v87, v16
    v_max3_f32 v16, v88, v89, v16
    v_max3_f32 v16, v90, v91, v16
    v_max3_f32 v16, v92, v93, v16
    v_max3_f32 v16, v94, v95, v16
    s_cmp_lg_u32 s12, 0
    s_cbranch_scc1 l2_kernel_ml
    v_mov_b32 v17, v16
    ds_read_b128 v[128:131], v10
    ds_read_b128 v[132:135], v10 offset:1024
    v_permlane32_swap_b32 v16, v17
    ds_read_b128 v[136:139], v10 offset:4096
    v_max_f32 v16, v16, v17
    v_xor_b32 v112, 0x80000000, v16
    v_xor_b32 v113, 0x80000000, v16
    v_xor_b32 v114, 0x80000000, v16
    v_xor_b32 v115, 0x80000000, v16
    v_xor_b32 v116, 0x80000000, v16
    v_xor_b32 v117, 0x80000000, v16
    v_xor_b32 v118, 0x80000000, v16
    v_xor_b32 v119, 0x80000000, v16
    v_xor_b32 v120, 0x80000000, v16
    v_xor_b32 v121, 0x80000000, v16
    v_xor_b32 v122, 0x80000000, v16
    v_xor_b32 v123, 0x80000000, v16
    v_xor_b32 v124, 0x80000000, v16
    v_xor_b32 v125, 0x80000000, v16
    v_xor_b32 v126, 0x80000000, v16
    v_xor_b32 v127, 0x80000000, v16
    v_mov_b32 v96, 0
    v_mov_b32 v97, 0
    v_mov_b32 v98, 0
    v_mov_b32 v99, 0
    v_mov_b32 v100, 0
    v_mov_b32 v101, 0
    v_mov_b32 v102, 0
    v_mov_b32 v103, 0
    v_mov_b32 v104, 0
    v_mov_b32 v105, 0
    v_mov_b32 v106, 0
    v_mov_b32 v107, 0
    v_mov_b32 v108, 0
    v_mov_b32 v109, 0
    v_mov_b32 v110, 0
    v_mov_b32 v111, 0
    v_mov_b32 v88, 0
    v_mov_b32 v89, 0
    v_mov_b32 v90, 0
    v_mov_b32 v91, 0
    s_mov_b32 s6, 0
    s_mov_b32 s8, 40960
    v_mov_b32 v13, v11
    v_mov_b32 v18, v10
    v_add_u32 v12, s8, v10
    v_add_u32 v14, s8, v11
    s_waitcnt lgkmcnt(2)
    v_mfma_f32_32x32x16_bf16 v[32:47], v[128:131], v[156:159], v[112:127]
    s_waitcnt lgkmcnt(1)
    v_mfma_f32_32x32x16_bf16 v[48:63], v[132:135], v[156:159], v[112:127]
    s_mov_b64 exec, s[60:61]
    ds_read_b128 v[140:143], v13
    s_mov_b64 exec, -1
    ds_read_b128 v[128:131], v10 offset:2048
    ds_read_b128 v[132:135], v10 offset:3072
    s_mov_b64 exec, s[60:61]
    ds_read_b128 v[144:147], v13 offset:640
    ds_read_b128 v[148:151], v13 offset:1280
    s_mov_b64 exec, -1
    s_waitcnt lgkmcnt(5)
    v_mfma_f32_32x32x4_2b_bf16 v[32:63], v[136:137], v[160:161], v[32:63]
    s_nop 7
    s_nop 7
    s_nop 1
    s_branch l2_kernel_join
l2_kernel_stub0:
    s_barrier
    s_branch l2_kernel_back0
l2_kernel_stub1:
    s_cmp_lg_u32 s6, 13
    s_cbranch_scc1 l2_kernel_stubb1
    s_setprio 0
    s_branch l2_kernel_back1
l2_kernel_stubb1:
    s_barrier
    s_branch l2_kernel_back1
l2_kernel_ffn:
    s_setprio 3
    v_lshlrev_b32 v42, 4, v0
    s_mov_b32 s10, 8028160
    s_waitcnt lgkmcnt(0)
    s_mov_b32 s44, s40
    s_and_b32 s45, s41, 0xffff
    s_mov_b32 s46, 9437184
    s_mov_b32 s47, 0x00020000
    s_cmp_ge_u32 s2, 216
    s_cbranch_scc1 l2_kernel_dmaonly
    buffer_load_dwordx4 v[2:5], v42, s[44:47], s10 offen offset:0
    buffer_load_dwordx4 v[6:9], v42, s[44:47], s10 offen offset:1024
    buffer_load_dwordx4 v[10:13], v42, s[44:47], s10 offen offset:2048
    buffer_load_dwordx4 v[14:17], v42, s[44:47], s10 offen offset:3072
    s_add_u32 s10, s10, 4096
    buffer_load_dwordx4 v[18:21], v42, s[44:47], s10 offen offset:0
    buffer_load_dwordx4 v[22:25], v42, s[44:47], s10 offen offset:1024
    buffer_load_dwordx4 v[26:29], v42, s[44:47], s10 offen offset:2048
    buffer_load_dwordx4 v[30:33], v42, s[44:47], s10 offen offset:3072
    s_mov_b32 s48, s30
    s_and_b32 s49, s31, 0xffff
    s_mov_b32 s50, 2211840
    s_mov_b32 s51, 0x00020000
    s_mov_b32 s52, s32
    s_and_b32 s53, s33, 0xffff
    s_mov_b32 s54, 2211840
    s_mov_b32 s55, 0x00020000
    s_mov_b32 s56, s16
    s_and_b32 s57, s17, 0xffff
    s_mov_b32 s58, 2621440
    s_mov_b32 s59, 0x00020000
    v_lshrrev_b32 v1, 4, v0
    v_and_b32 v45, 15, v0
    v_bfe_u32 v46, v0, 1, 1
    v_mul_u32_u24 v46, 320, v46
    v_lshl_add_u32 v46, v1, 3, v46
    v_and_b32 v47, 1, v0
    v_add_u32 v46, v46, v47
    v_mul_u32_u24 v46, 3456, v46
    v_and_b32 v43, 12, v0
    v_add_u32 v43, v43, v46
    v_lshrrev_b32 v46, 5, v0
    v_and_b32 v167, 31, v0
    v_mul_u32_u24 v46, 640, v46
    v_lshl_add_u32 v44, v167, 2, v46
    v_and_b32 v46, 4, v0
    v_lshlrev_b32 v46, 5, v46
    v_lshl_add_u32 v164, v1, 4, v46
    v_and_b32 v46, 2, v0
    v_mul_u32_u24 v46, 0x101, v46
    v_add_u32 v46, 0x0c0c0100, v46
    v_lshlrev_b32 v47, 4, v47
    v_alignbit_b32 v155, v46, v46, v47
    v_lshlrev_b32 v46, 1, v1
    v_sub_u32 v46, v45, v46
    v_mov_b32 v47, 0xffff
    v_cmp_eq_u32 vcc, 0, v46
    v_cmp_eq_u32 s[62:63], 1, v46
    v_lshlrev_b32 v167, 16, v47
    v_cndmask_b32 v165, 0, v47, vcc
    v_lshl_add_u32 v166, v1, 3, v45
    v_cndmask_b32 v165, v165, v167, s[62:63]
    v_lshlrev_b32 v166, 2, v166
    v_mov_b32 v167, 0
    s_and_b32 s68, s2, 7
    s_mul_i32 s68, s68, 27
    s_lshr_b32 s9, s2, 3
    s_add_u32 s68, s68, s9
    s_barrier
    s_mov_b32 m0, 24576
    s_mov_b32 s14, 7888896
    buffer_load_dwordx4 v42, s[44:47], s14 offen lds
    s_mov_b32 m0, 25600
    s_mov_b32 s14, 7889920
    buffer_load_dwordx4 v42, s[44:47], s14 offen lds
    s_mov_b32 m0, 26624
    s_mov_b32 s14, 7890944
    buffer_load_dwordx4 v42, s[44:47], s14 offen lds
    s_mov_b32 m0, 27648
    s_mov_b32 s14, 7891968
    buffer_load_dwordx4 v42, s[44:47], s14 offen lds
    s_mov_b32 m0, 28672
    s_mov_b32 s14, 7892992
    buffer_load_dwordx4 v42, s[44:47], s14 offen lds
    s_mov_b32 m0, 29696
    s_mov_b32 s14, 7894016
    buffer_load_dwordx4 v42, s[44:47], s14 offen lds
    s_mov_b32 m0, 30720
    s_mov_b32 s14, 7895040
    buffer_load_dwordx4 v42, s[44:47], s14 offen lds
    s_mov_b32 m0, 31744
    s_mov_b32 s14, 7896064
    buffer_load_dwordx4 v42, s[44:47], s14 offen lds
    s_mov_b32 m0, 32768
    s_mov_b32 s14, 7897088
    buffer_load_dwordx4 v42, s[44:47], s14 offen lds
    s_mov_b32 m0, 33792
    s_mov_b32 s14, 7898112
    buffer_load_dwordx4 v42, s[44:47], s14 offen lds
    s_mov_b32 m0, 34816
    s_mov_b32 s14, 7899136
    buffer_load_dwordx4 v42, s[44:47], s14 offen lds
    s_mov_b32 m0, 35840
    s_mov_b32 s14, 7900160
    buffer_load_dwordx4 v42, s[44:47], s14 offen lds
    s_mov_b32 m0, 36864
    s_mov_b32 s14, 7901184
    buffer_load_dwordx4 v42, s[44:47], s14 offen lds
    s_mov_b32 m0, 37888
    s_mov_b32 s14, 7902208
    buffer_load_dwordx4 v42, s[44:47], s14 offen lds
    s_mov_b32 m0, 38912
    s_mov_b32 s14, 7903232
    buffer_load_dwordx4 v42, s[44:47], s14 offen lds
    s_mov_b32 m0, 39936
    s_mov_b32 s14, 7904256
    buffer_load_dwordx4 v42, s[44:47], s14 offen lds
    s_mov_b32 m0, 40960
    s_mov_b32 s14, 7905280
    buffer_load_dwordx4 v42, s[44:47], s14 offen lds
    s_mov_b32 m0, 41984
    s_mov_b32 s14, 7906304
    buffer_load_dwordx4 v42, s[44:47], s14 offen lds
    s_mov_b32 m0, 43008
    s_mov_b32 s14, 7907328
    buffer_load_dwordx4 v42, s[44:47], s14 offen lds
    s_mov_b32 m0, 44032
    s_mov_b32 s14, 7908352
    buffer_load_dwordx4 v42, s[44:47], s14 offen lds
    s_mov_b32 m0, 45056
    s_mov_b32 s14, 7909376
    buffer_load_dwordx4 v42, s[44:47], s14 offen lds
    s_mov_b32 m0, 46080
    s_mov_b32 s14, 7910400
    buffer_load_dwordx4 v42, s[44:47], s14 offen lds
    s_mov_b32 m0, 47104
    s_mov_b32 s14, 7911424
    buffer_load_dwordx4 v42, s[44:47], s14 offen lds
    s_mov_b32 m0, 48128
    s_mov_b32 s14, 7912448
    buffer_load_dwordx4 v42, s[44:47], s14 offen lds
    s_mov_b32 m0, 49152
    s_mov_b32 s14, 7913472
    buffer_load_dwordx4 v42, s[44:47], s14 offen lds
    s_mov_b32 m0, 50176
    s_mov_b32 s14, 7914496
    buffer_load_dwordx4 v42, s[44:47], s14 offen lds
    s_mov_b32 m0, 51200
    s_mov_b32 s14, 7915520
    buffer_load_dwordx4 v42, s[44:47], s14 offen lds
    s_mov_b32 m0, 52224
    s_mov_b32 s14, 7916544
    buffer_load_dwordx4 v42, s[44:47], s14 offen lds
    s_mov_b32 m0, 53248
    s_mov_b32 s14, 7917568
    buffer_load_dwordx4 v42, s[44:47], s14 offen lds
    s_mov_b32 m0, 54272
    s_mov_b32 s14, 7918592
    buffer_load_dwordx4 v42, s[44:47], s14 offen lds
    s_mov_b32 m0, 55296
    s_mov_b32 s14, 7919616
    buffer_load_dwordx4 v42, s[44:47], s14 offen lds
    s_mov_b32 m0, 56320
    s_mov_b32 s14, 7920640
    buffer_load_dwordx4 v42, s[44:47], s14 offen lds
    s_waitcnt vmcnt(32)
    v_max_u32 v45, v2, v3
    v_max3_u32 v45, v4, v5, v45
    v_max3_u32 v45, v6, v7, v45
    v_max3_u32 v45, v8, v9, v45
    v_max3_u32 v45, v10, v11, v45
    v_max3_u32 v45, v12, v13, v45
    v_max3_u32 v45, v14, v15, v45
    v_max3_u32 v45, v16, v17, v45
    v_max3_u32 v45, v18, v19, v45
    v_max3_u32 v45, v20, v21, v45
    v_max3_u32 v45, v22, v23, v45
    v_max3_u32 v45, v24, v25, v45
    v_max3_u32 v45, v26, v27, v45
    v_max3_u32 v45, v28, v29, v45
    v_max3_u32 v45, v30, v31, v45
    v_max3_u32 v45, v32, v33, v45
    s_nop 1
    v_max_u32_dpp v45, v45, v45 row_ror:8 row_mask:0xf bank_mask:0xf
    s_nop 1
    v_max_u32_dpp v45, v45, v45 row_ror:4 row_mask:0xf bank_mask:0xf
    s_nop 1
    v_max_u32_dpp v45, v45, v45 row_ror:2 row_mask:0xf bank_mask:0xf
    s_nop 1
    v_max_u32_dpp v45, v45, v45 row_ror:1 row_mask:0xf bank_mask:0xf
    v_mov_b32 v46, v45
    s_nop 1
    v_permlane16_swap_b32 v45, v46
    v_max_u32 v45, v45, v46
    v_mov_b32 v46, v45
    s_nop 1
    v_permlane32_swap_b32 v45, v46
    v_max_u32 v45, v45, v46
    v_lshlrev_b32 v46, 2, v0
    v_readfirstlane_b32 s11, v45
    s_and_b32 s6, s11, 0xffff
    s_sub_u32 s6, 0xffff, s6
    s_and_b32 s6, s6, 2047
    s_mul_i32 s10, s6, 1280
    s_lshl_b32 s12, s6, 3
    s_add_u32 s12, s12, 5242880
    buffer_load_dword v148, v44, s[56:59], s10 offen offset:0
    buffer_load_dword v149, v44, s[56:59], s10 offen offset:128
    buffer_load_dword v150, v44, s[56:59], s10 offen offset:256
    buffer_load_dword v151, v44, s[56:59], s10 offen offset:384
    buffer_load_dword v152, v44, s[56:59], s10 offen offset:512
    buffer_load_dwordx2 v[162:163], v167, s[44:47], s12 offen
    s_mov_b32 m0, 57344
    s_mov_b32 s14, 7921664
    buffer_load_dwordx4 v42, s[44:47], s14 offen lds
    s_mov_b32 m0, 58368
    s_mov_b32 s14, 7922688
    buffer_load_dwordx4 v42, s[44:47], s14 offen lds
    s_mov_b32 m0, 59392
    s_mov_b32 s14, 7923712
    buffer_load_dwordx4 v42, s[44:47], s14 offen lds
    s_mov_b32 m0, 60416
    s_mov_b32 s14, 7924736
    buffer_load_dwordx4 v42, s[44:47], s14 offen lds
    s_mov_b32 m0, 61440
    s_mov_b32 s14, 7925760
    buffer_load_dwordx4 v42, s[44:47], s14 offen lds
    s_mov_b32 m0, 62464
    s_mov_b32 s14, 7926784
    buffer_load_dwordx4 v42, s[44:47], s14 offen lds
    s_mov_b32 m0, 63488
    s_mov_b32 s14, 7927808
    buffer_load_dwordx4 v42, s[44:47], s14 offen lds
    s_mov_b32 m0, 64512
    s_mov_b32 s14, 7928832
    buffer_load_dwordx4 v42, s[44:47], s14 offen lds
    s_mov_b32 m0, 65536
    s_mov_b32 s14, 7929856
    buffer_load_dwordx4 v42, s[44:47], s14 offen lds
    s_mov_b32 m0, 66560
    s_mov_b32 s14, 7930880
    buffer_load_dwordx4 v42, s[44:47], s14 offen lds
    s_mov_b32 m0, 67584
    s_mov_b32 s14, 7931904
    buffer_load_dwordx4 v42, s[44:47], s14 offen lds
    s_mov_b32 m0, 68608
    s_mov_b32 s14, 7932928
    buffer_load_dwordx4 v42, s[44:47], s14 offen lds
    s_mov_b32 m0, 69632
    s_mov_b32 s14, 7933952
    buffer_load_dwordx4 v42, s[44:47], s14 offen lds
    s_mov_b32 m0, 70656
    s_mov_b32 s14, 7934976
    buffer_load_dwordx4 v42, s[44:47], s14 offen lds
    s_mov_b32 m0, 71680
    s_mov_b32 s14, 7936000
    buffer_load_dwordx4 v42, s[44:47], s14 offen lds
    s_mov_b32 m0, 72704
    s_mov_b32 s14, 7937024
    buffer_load_dwordx4 v42, s[44:47], s14 offen lds
    s_mov_b32 m0, 73728
    s_mov_b32 s14, 7938048
    buffer_load_dwordx4 v42, s[44:47], s14 offen lds
    s_mov_b32 m0, 74752
    s_mov_b32 s14, 7939072
    buffer_load_dwordx4 v42, s[44:47], s14 offen lds
    s_mov_b32 m0, 75776
    s_mov_b32 s14, 7940096
    buffer_load_dwordx4 v42, s[44:47], s14 offen lds
    s_mov_b32 m0, 76800
    s_mov_b32 s14, 7941120
    buffer_load_dwordx4 v42, s[44:47], s14 offen lds
    s_mov_b32 m0, 77824
    s_mov_b32 s14, 7942144
    buffer_load_dwordx4 v42, s[44:47], s14 offen lds
    s_mov_b32 m0, 78848
    s_mov_b32 s14, 7943168
    buffer_load_dwordx4 v42, s[44:47], s14 offen lds
    s_mov_b32 m0, 79872
    s_mov_b32 s14, 7944192
    buffer_load_dwordx4 v42, s[44:47], s14 offen lds
    s_mov_b32 m0, 80896
    s_mov_b32 s14, 7945216
    buffer_load_dwordx4 v42, s[44:47], s14 offen lds
    s_mov_b32 m0, 81920
    s_mov_b32 s14, 7946240
    buffer_load_dwordx4 v42, s[44:47], s14 offen lds
    s_mov_b32 m0, 82944
    s_mov_b32 s14, 7947264
    buffer_load_dwordx4 v42, s[44:47], s14 offen lds
    s_mov_b32 m0, 83968
    s_mov_b32 s14, 7948288
    buffer_load_dwordx4 v42, s[44:47], s14 offen lds
    s_mov_b32 m0, 84992
    s_mov_b32 s14, 7949312
    buffer_load_dwordx4 v42, s[44:47], s14 offen lds
    s_mov_b32 m0, 86016
    s_mov_b32 s14, 7950336
    buffer_load_dwordx4 v42, s[44:47], s14 offen lds
    s_mov_b32 m0, 87040
    s_mov_b32 s14, 7951360
    buffer_load_dwordx4 v42, s[44:47], s14 offen lds
    s_mov_b32 m0, 88064
    s_mov_b32 s14, 7952384
    buffer_load_dwordx4 v42, s[44:47], s14 offen lds
    s_mov_b32 m0, 89088
    s_mov_b32 s14, 7953408
    buffer_load_dwordx4 v42, s[44:47], s14 offen lds
    s_mov_b32 m0, 90112
    s_mov_b32 s14, 7954432
    buffer_load_dwordx4 v42, s[44:47], s14 offen lds
    s_mov_b32 m0, 91136
    s_mov_b32 s14, 7955456
    buffer_load_dwordx4 v42, s[44:47], s14 offen lds
    s_mov_b32 m0, 92160
    s_mov_b32 s14, 7956480
    buffer_load_dwordx4 v42, s[44:47], s14 offen lds
    s_mov_b32 m0, 93184
    s_mov_b32 s14, 7957504
    buffer_load_dwordx4 v42, s[44:47], s14 offen lds
    s_mov_b32 m0, 94208
    s_mov_b32 s14, 7958528
    buffer_load_dwordx4 v42, s[44:47], s14 offen lds
    s_mov_b32 m0, 95232
    s_mov_b32 s14, 7959552
    buffer_load_dwordx4 v42, s[44:47], s14 offen lds
    s_mov_b32 m0, 96256
    s_mov_b32 s14, 7960576
    buffer_load_dwordx4 v42, s[44:47], s14 offen lds
    s_mov_b32 m0, 97280
    s_mov_b32 s14, 7961600
    buffer_load_dwordx4 v42, s[44:47], s14 offen lds
    s_mov_b32 m0, 98304
    s_mov_b32 s14, 7962624
    buffer_load_dwordx4 v42, s[44:47], s14 offen lds
    s_mov_b32 m0, 99328
    s_mov_b32 s14, 7963648
    buffer_load_dwordx4 v42, s[44:47], s14 offen lds
    s_mov_b32 m0, 100352
    s_mov_b32 s14, 7964672
    buffer_load_dwordx4 v42, s[44:47], s14 offen lds
    s_mov_b32 m0, 101376
    s_mov_b32 s14, 7965696
    buffer_load_dwordx4 v42, s[44:47], s14 offen lds
    s_mov_b32 m0, 102400
    s_mov_b32 s14, 7966720
    buffer_load_dwordx4 v42, s[44:47], s14 offen lds
    s_mov_b32 m0, 103424
    s_mov_b32 s14, 7967744
    buffer_load_dwordx4 v42, s[44:47], s14 offen lds
    s_mov_b32 m0, 104448
    s_mov_b32 s14, 7968768
    buffer_load_dwordx4 v42, s[44:47], s14 offen lds
    s_mov_b32 m0, 105472
    s_mov_b32 s14, 7969792
    buffer_load_dwordx4 v42, s[44:47], s14 offen lds
    s_waitcnt vmcnt(54)
    s_barrier
    s_mov_b32 m0, 106496
    s_mov_b32 s14, 7970816
    buffer_load_dwordx4 v42, s[44:47], s14 offen lds
    s_mov_b32 m0, 107520
    s_mov_b32 s14, 7971840
    buffer_load_dwordx4 v42, s[44:47], s14 offen lds
    s_mov_b32 m0, 108544
    s_mov_b32 s14, 7972864
    buffer_load_dwordx4 v42, s[44:47], s14 offen lds
    s_mov_b32 m0, 109568
    s_mov_b32 s14, 7973888
    buffer_load_dwordx4 v42, s[44:47], s14 offen lds
    s_mov_b32 m0, 110592
    s_mov_b32 s14, 7974912
    buffer_load_dwordx4 v42, s[44:47], s14 offen lds
    s_mov_b32 m0, 111616
    s_mov_b32 s14, 7975936
    buffer_load_dwordx4 v42, s[44:47], s14 offen lds
    s_mov_b32 m0, 112640
    s_mov_b32 s14, 7976960
    buffer_load_dwordx4 v42, s[44:47], s14 offen lds
    s_mov_b32 m0, 113664
    s_mov_b32 s14, 7977984
    buffer_load_dwordx4 v42, s[44:47], s14 offen lds
    s_mov_b32 m0, 114688
    s_mov_b32 s14, 7979008
    buffer_load_dwordx4 v42, s[44:47], s14 offen lds
    s_mov_b32 m0, 115712
    s_mov_b32 s14, 7980032
    buffer_load_dwordx4 v42, s[44:47], s14 offen lds
    s_mov_b32 m0, 116736
    s_mov_b32 s14, 7981056
    buffer_load_dwordx4 v42, s[44:47], s14 offen lds
    s_mov_b32 m0, 117760
    s_mov_b32 s14, 7982080
    buffer_load_dwordx4 v42, s[44:47], s14 offen lds
    s_mov_b32 m0, 118784
    s_mov_b32 s14, 7983104
    buffer_load_dwordx4 v42, s[44:47], s14 offen lds
    s_mov_b32 m0, 119808
    s_mov_b32 s14, 7984128
    buffer_load_dwordx4 v42, s[44:47], s14 offen lds
    s_mov_b32 m0, 120832
    s_mov_b32 s14, 7985152
    buffer_load_dwordx4 v42, s[44:47], s14 offen lds
    s_mov_b32 m0, 121856
    s_mov_b32 s14, 7986176
    buffer_load_dwordx4 v42, s[44:47], s14 offen lds
    s_mov_b32 m0, 122880
    s_mov_b32 s14, 7987200
    buffer_load_dwordx4 v42, s[44:47], s14 offen lds
    s_mov_b32 m0, 123904
    s_mov_b32 s14, 7988224
    buffer_load_dwordx4 v42, s[44:47], s14 offen lds
    s_mov_b32 m0, 124928
    s_mov_b32 s14, 7989248
    buffer_load_dwordx4 v42, s[44:47], s14 offen lds
    s_mov_b32 m0, 125952
    s_mov_b32 s14, 7990272
    buffer_load_dwordx4 v42, s[44:47], s14 offen lds
    s_mov_b32 m0, 126976
    s_mov_b32 s14, 7991296
    buffer_load_dwordx4 v42, s[44:47], s14 offen lds
    s_mov_b32 m0, 128000
    s_mov_b32 s14, 7992320
    buffer_load_dwordx4 v42, s[44:47], s14 offen lds
    s_mov_b32 m0, 129024
    s_mov_b32 s14, 7993344
    buffer_load_dwordx4 v42, s[44:47], s14 offen lds
    s_mov_b32 m0, 130048
    s_mov_b32 s14, 7994368
    buffer_load_dwordx4 v42, s[44:47], s14 offen lds
    s_mov_b32 m0, 131072
    s_mov_b32 s14, 7995392
    buffer_load_dwordx4 v42, s[44:47], s14 offen lds
    s_mov_b32 m0, 132096
    s_mov_b32 s14, 7996416
    buffer_load_dwordx4 v42, s[44:47], s14 offen lds
    s_mov_b32 m0, 133120
    s_mov_b32 s14, 7997440
    buffer_load_dwordx4 v42, s[44:47], s14 offen lds
    s_mov_b32 m0, 134144
    s_mov_b32 s14, 7998464
    buffer_load_dwordx4 v42, s[44:47], s14 offen lds
    s_mov_b32 m0, 135168
    s_mov_b32 s14, 7999488
    buffer_load_dwordx4 v42, s[44:47], s14 offen lds
    s_mov_b32 m0, 136192
    s_mov_b32 s14, 8000512
    buffer_load_dwordx4 v42, s[44:47], s14 offen lds
    s_mov_b32 m0, 137216
    s_mov_b32 s14, 8001536
    buffer_load_dwordx4 v42, s[44:47], s14 offen lds
    s_mov_b32 m0, 138240
    s_mov_b32 s14, 8002560
    buffer_load_dwordx4 v42, s[44:47], s14 offen lds
    s_mov_b32 m0, 139264
    s_mov_b32 s14, 8003584
    buffer_load_dwordx4 v42, s[44:47], s14 offen lds
    s_mov_b32 m0, 140288
    s_mov_b32 s14, 8004608
    buffer_load_dwordx4 v42, s[44:47], s14 offen lds
    s_mov_b32 m0, 141312
    s_mov_b32 s14, 8005632
    buffer_load_dwordx4 v42, s[44:47], s14 offen lds
    s_mov_b32 m0, 142336
    s_mov_b32 s14, 8006656
    buffer_load_dwordx4 v42, s[44:47], s14 offen lds
    s_mov_b32 m0, 143360
    s_mov_b32 s14, 8007680
    buffer_load_dwordx4 v42, s[44:47], s14 offen lds
    s_mov_b32 m0, 144384
    s_mov_b32 s14, 8008704
    buffer_load_dwordx4 v42, s[44:47], s14 offen lds
    s_mov_b32 m0, 145408
    s_mov_b32 s14, 8009728
    buffer_load_dwordx4 v42, s[44:47], s14 offen lds
    s_mov_b32 m0, 146432
    s_mov_b32 s14, 8010752
    buffer_load_dwordx4 v42, s[44:47], s14 offen lds
    s_mov_b32 m0, 147456
    s_mov_b32 s14, 8011776
    buffer_load_dwordx4 v42, s[44:47], s14 offen lds
    s_mov_b32 m0, 148480
    s_mov_b32 s14, 8012800
    buffer_load_dwordx4 v42, s[44:47], s14 offen lds
    s_mov_b32 m0, 149504
    s_mov_b32 s14, 8013824
    buffer_load_dwordx4 v42, s[44:47], s14 offen lds
    s_mov_b32 m0, 150528
    s_mov_b32 s14, 8014848
    buffer_load_dwordx4 v42, s[44:47], s14 offen lds
    s_mov_b32 m0, 151552
    s_mov_b32 s14, 8015872
    buffer_load_dwordx4 v42, s[44:47], s14 offen lds
    s_mov_b32 m0, 152576
    s_mov_b32 s14, 8016896
    buffer_load_dwordx4 v42, s[44:47], s14 offen lds
    s_mov_b32 m0, 153600
    s_mov_b32 s14, 8017920
    buffer_load_dwordx4 v42, s[44:47], s14 offen lds
    s_mov_b32 m0, 154624
    s_mov_b32 s14, 8018944
    buffer_load_dwordx4 v42, s[44:47], s14 offen lds
    s_mov_b32 m0, 155648
    s_mov_b32 s14, 8019968
    buffer_load_dwordx4 v42, s[44:47], s14 offen lds
    s_mov_b32 m0, 156672
    s_mov_b32 s14, 8020992
    buffer_load_dwordx4 v42, s[44:47], s14 offen lds
    s_mov_b32 m0, 157696
    s_mov_b32 s14, 8022016
    buffer_load_dwordx4 v42, s[44:47], s14 offen lds
    s_mov_b32 m0, 158720
    s_mov_b32 s14, 8023040
    buffer_load_dwordx4 v42, s[44:47], s14 offen lds
    s_mov_b32 m0, 159744
    s_mov_b32 s14, 8024064
    buffer_load_dwordx4 v42, s[44:47], s14 offen lds
    s_mov_b32 m0, 160768
    s_mov_b32 s14, 8025088
    buffer_load_dwordx4 v42, s[44:47], s14 offen lds
    s_mov_b32 m0, 161792
    s_mov_b32 s14, 8026112
    buffer_load_dwordx4 v42, s[44:47], s14 offen lds
    s_mov_b32 m0, 162816
    s_mov_b32 s14, 8027136
    buffer_load_dwordx4 v42, s[44:47], s14 offen lds
    s_mov_b32 s56, s34
    s_and_b32 s57, s35, 0xffff
    s_mov_b32 s58, 2211840
    s_mov_b32 s59, 0x00020000
    s_mul_i32 s10, s68, 10240
    s_lshl_b32 s9, s68, 4
    buffer_load_dword v48, v43, s[48:51], s9 offen
    buffer_load_dword v88, v43, s[52:55], s9 offen
    s_add_u32 s9, s9, 6912
    buffer_load_dword v49, v43, s[48:51], s9 offen
    buffer_load_dword v89, v43, s[52:55], s9 offen
    s_add_u32 s9, s9, 6912
    buffer_load_dword v50, v43, s[48:51], s9 offen
    buffer_load_dword v90, v43, s[52:55], s9 offen
    s_add_u32 s9, s9, 6912
    buffer_load_dword v51, v43, s[48:51], s9 offen
    buffer_load_dword v91, v43, s[52:55], s9 offen
    s_add_u32 s9, s9, 89856
    buffer_load_dword v52, v43, s[48:51], s9 offen
    buffer_load_dword v92, v43, s[52:55], s9 offen
    s_add_u32 s9, s9, 6912
    buffer_load_dword v53, v43, s[48:51], s9 offen
    buffer_load_dword v93, v43, s[52:55], s9 offen
    s_add_u32 s9, s9, 6912
    buffer_load_dword v54, v43, s[48:51], s9 offen
    buffer_load_dword v94, v43, s[52:55], s9 offen
    s_add_u32 s9, s9, 6912
    buffer_load_dword v55, v43, s[48:51], s9 offen
    buffer_load_dword v95, v43, s[52:55], s9 offen
    s_add_u32 s9, s9, 89856
    v_mov_b32 v45, 0xffff0000
    s_waitcnt vmcnt(63)
    v_lshlrev_b32 v156, 16, v148
    v_and_b32 v157, v45, v148
    v_pk_add_f32 v[156:157], v[156:157], v[162:163] op_sel_hi:[1,0] neg_lo:[0,1] neg_hi:[0,1]
    v_cvt_pk_bf16_f32 v157, v156, v157
    v_lshlrev_b32 v156, 16, v157
    v_and_b32 v157, v45, v157
    v_pk_mul_f32 v[156:157], v[156:157], v[162:163] op_sel:[0,1]
    v_cvt_pk_bf16_f32 v148, v156, v157
    v_lshlrev_b32 v158, 16, v149
    v_and_b32 v159, v45, v149
    v_pk_add_f32 v[158:159], v[158:159], v[162:163] op_sel_hi:[1,0] neg_lo:[0,1] neg_hi:[0,1]
    v_cvt_pk_bf16_f32 v159, v158, v159
    v_lshlrev_b32 v158, 16, v159
    v_and_b32 v159, v45, v159
    v_pk_mul_f32 v[158:159], v[158:159], v[162:163] op_sel:[0,1]
    v_cvt_pk_bf16_f32 v149, v158, v159
    v_lshlrev_b32 v156, 16, v150
    v_and_b32 v157, v45, v150
    v_pk_add_f32 v[156:157], v[156:157], v[162:163] op_sel_hi:[1,0] neg_lo:[0,1] neg_hi:[0,1]
    v_cvt_pk_bf16_f32 v157, v156, v157
    v_lshlrev_b32 v156, 16, v157
    v_and_b32 v157, v45, v157
    v_pk_mul_f32 v[156:157], v[156:157], v[162:163] op_sel:[0,1]
    v_cvt_pk_bf16_f32 v150, v156, v157
    v_lshlrev_b32 v158, 16, v151
    v_and_b32 v159, v45, v151
    v_pk_add_f32 v[158:159], v[158:159], v[162:163] op_sel_hi:[1,0] neg_lo:[0,1] neg_hi:[0,1]
    v_cvt_pk_bf16_f32 v159, v158, v159
    v_lshlrev_b32 v158, 16, v159
    v_and_b32 v159, v45, v159
    v_pk_mul_f32 v[158:159], v[158:159], v[162:163] op_sel:[0,1]
    v_cvt_pk_bf16_f32 v151, v158, v159
    v_lshlrev_b32 v156, 16, v152
    v_and_b32 v157, v45, v152
    v_pk_add_f32 v[156:157], v[156:157], v[162:163] op_sel_hi:[1,0] neg_lo:[0,1] neg_hi:[0,1]
    v_cvt_pk_bf16_f32 v157, v156, v157
    v_lshlrev_b32 v156, 16, v157
    v_and_b32 v157, v45, v157
    v_pk_mul_f32 v[156:157], v[156:157], v[162:163] op_sel:[0,1]
    v_cvt_pk_bf16_f32 v152, v156, v157
    buffer_load_dword v56, v43, s[48:51], s9 offen
    buffer_load_dword v96, v43, s[52:55], s9 offen
    s_add_u32 s9, s9, 6912
    buffer_load_dword v57, v43, s[48:51], s9 offen
    buffer_load_dword v97, v43, s[52:55], s9 offen
    s_add_u32 s9, s9, 6912
    buffer_load_dword v58, v43, s[48:51], s9 offen
    buffer_load_dword v98, v43, s[52:55], s9 offen
    s_add_u32 s9, s9, 6912
    buffer_load_dword v59, v43, s[48:51], s9 offen
    buffer_load_dword v99, v43, s[52:55], s9 offen
    s_add_u32 s9, s9, 89856
    buffer_load_dword v60, v43, s[48:51], s9 offen
    buffer_load_dword v100, v43, s[52:55], s9 offen
    s_add_u32 s9, s9, 6912
    buffer_load_dword v61, v43, s[48:51], s9 offen
    buffer_load_dword v101, v43, s[52:55], s9 offen
    s_add_u32 s9, s9, 6912
    buffer_load_dword v62, v43, s[48:51], s9 offen
    buffer_load_dword v102, v43, s[52:55], s9 offen
    s_add_u32 s9, s9, 6912
    buffer_load_dword v63, v43, s[48:51], s9 offen
    buffer_load_dword v103, v43, s[52:55], s9 offen
    s_add_u32 s9, s9, 89856
    buffer_load_dword v64, v43, s[48:51], s9 offen
    buffer_load_dword v104, v43, s[52:55], s9 offen
    s_add_u32 s9, s9, 6912
    buffer_load_dword v65, v43, s[48:51], s9 offen
    buffer_load_dword v105, v43, s[52:55], s9 offen
    s_add_u32 s9, s9, 6912
    buffer_load_dword v66, v43, s[48:51], s9 offen
    buffer_load_dword v106, v43, s[52:55], s9 offen
    s_add_u32 s9, s9, 6912
    buffer_load_dword v67, v43, s[48:51], s9 offen
    buffer_load_dword v107, v43, s[52:55], s9 offen
    s_add_u32 s9, s9, 89856
    buffer_load_dword v68, v43, s[48:51], s9 offen
    buffer_load_dword v108, v43, s[52:55], s9 offen
    s_add_u32 s9, s9, 6912
    buffer_load_dword v69, v43, s[48:51], s9 offen
    buffer_load_dword v109, v43, s[52:55], s9 offen
    s_add_u32 s9, s9, 6912
    buffer_load_dword v70, v43, s[48:51], s9 offen
    buffer_load_dword v110, v43, s[52:55], s9 offen
    s_add_u32 s9, s9, 6912
    buffer_load_dword v71, v43, s[48:51], s9 offen
    buffer_load_dword v111, v43, s[52:55], s9 offen
    s_add_u32 s9, s9, 89856
    buffer_load_dword v72, v43, s[48:51], s9 offen
    buffer_load_dword v112, v43, s[52:55], s9 offen
    s_add_u32 s9, s9, 6912
    buffer_load_dword v73, v43, s[48:51], s9 offen
    buffer_load_dword v113, v43, s[52:55], s9 offen
    s_add_u32 s9, s9, 6912
    buffer_load_dword v74, v43, s[48:51], s9 offen
    buffer_load_dword v114, v43, s[52:55], s9 offen
    s_add_u32 s9, s9, 6912
    buffer_load_dword v75, v43, s[48:51], s9 offen
    buffer_load_dword v115, v43, s[52:55], s9 offen
    s_add_u32 s9, s9, 89856
    s_waitcnt vmcnt(56)
    s_barrier
    buffer_load_dword v76, v43, s[48:51], s9 offen
    buffer_load_dword v116, v43, s[52:55], s9 offen
    s_add_u32 s9, s9, 6912
    buffer_load_dword v77, v43, s[48:51], s9 offen
    buffer_load_dword v117, v43, s[52:55], s9 offen
    s_add_u32 s9, s9, 6912
    buffer_load_dword v78, v43, s[48:51], s9 offen
    buffer_load_dword v118, v43, s[52:55], s9 offen
    s_add_u32 s9, s9, 6912
    buffer_load_dword v79, v43, s[48:51], s9 offen
    buffer_load_dword v119, v43, s[52:55], s9 offen
    s_add_u32 s9, s9, 89856
    buffer_load_dword v80, v43, s[48:51], s9 offen
    buffer_load_dword v120, v43, s[52:55], s9 offen
    s_add_u32 s9, s9, 6912
    buffer_load_dword v81, v43, s[48:51], s9 offen
    buffer_load_dword v121, v43, s[52:55], s9 offen
    s_add_u32 s9, s9, 6912
    buffer_load_dword v82, v43, s[48:51], s9 offen
    buffer_load_dword v122, v43, s[52:55], s9 offen
    s_add_u32 s9, s9, 6912
    buffer_load_dword v83, v43, s[48:51], s9 offen
    buffer_load_dword v123, v43, s[52:55], s9 offen
    s_add_u32 s9, s9, 89856
    buffer_load_dword v84, v43, s[48:51], s9 offen
    buffer_load_dword v124, v43, s[52:55], s9 offen
    s_add_u32 s9, s9, 6912
    buffer_load_dword v85, v43, s[48:51], s9 offen
    buffer_load_dword v125, v43, s[52:55], s9 offen
    s_add_u32 s9, s9, 6912
    buffer_load_dword v86, v43, s[48:51], s9 offen
    buffer_load_dword v126, v43, s[52:55], s9 offen
    s_add_u32 s9, s9, 6912
    buffer_load_dword v87, v43, s[48:51], s9 offen
    buffer_load_dword v127, v43, s[52:55], s9 offen
    s_add_u32 s9, s9, 89856
    buffer_load_dword v2, v46, s[56:59], s10 offen offset:0
    buffer_load_dword v10, v46, s[56:59], s10 offen offset:256
    buffer_load_dword v18, v46, s[56:59], s10 offen offset:512
    buffer_load_dword v26, v46, s[56:59], s10 offen offset:768
    buffer_load_dword v34, v46, s[56:59], s10 offen offset:1024
    buffer_load_dword v3, v46, s[56:59], s10 offen offset:1280
    buffer_load_dword v11, v46, s[56:59], s10 offen offset:1536
    buffer_load_dword v19, v46, s[56:59], s10 offen offset:1792
    buffer_load_dword v27, v46, s[56:59], s10 offen offset:2048
    buffer_load_dword v35, v46, s[56:59], s10 offen offset:2304
    s_add_u32 s10, s10, 2560
    buffer_load_dword v4, v46, s[56:59], s10 offen offset:0
    buffer_load_dword v12, v46, s[56:59], s10 offen offset:256
    buffer_load_dword v20, v46, s[56:59], s10 offen offset:512
    buffer_load_dword v28, v46, s[56:59], s10 offen offset:768
    buffer_load_dword v36, v46, s[56:59], s10 offen offset:1024
    buffer_load_dword v5, v46, s[56:59], s10 offen offset:1280
    buffer_load_dword v13, v46, s[56:59], s10 offen offset:1536
    buffer_load_dword v21, v46, s[56:59], s10 offen offset:1792
    buffer_load_dword v29, v46, s[56:59], s10 offen offset:2048
    buffer_load_dword v37, v46, s[56:59], s10 offen offset:2304
    s_add_u32 s10, s10, 2560
    buffer_load_dword v6, v46, s[56:59], s10 offen offset:0
    buffer_load_dword v14, v46, s[56:59], s10 offen offset:256
    buffer_load_dword v22, v46, s[56:59], s10 offen offset:512
    buffer_load_dword v30, v46, s[56:59], s10 offen offset:768
    buffer_load_dword v38, v46, s[56:59], s10 offen offset:1024
    buffer_load_dword v7, v46, s[56:59], s10 offen offset:1280
    buffer_load_dword v15, v46, s[56:59], s10 offen offset:1536
    buffer_load_dword v23, v46, s[56:59], s10 offen offset:1792
    buffer_load_dword v31, v46, s[56:59], s10 offen offset:2048
    buffer_load_dword v39, v46, s[56:59], s10 offen offset:2304
    s_add_u32 s10, s10, 2560
    buffer_load_dword v8, v46, s[56:59], s10 offen offset:0
    buffer_load_dword v16, v46, s[56:59], s10 offen offset:256
    buffer_load_dword v24, v46, s[56:59], s10 offen offset:512
    buffer_load_dword v32, v46, s[56:59], s10 offen offset:768
    buffer_load_dword v40, v46, s[56:59], s10 offen offset:1024
    buffer_load_dword v9, v46, s[56:59], s10 offen offset:1280
    buffer_load_dword v17, v46, s[56:59], s10 offen offset:1536
    buffer_load_dword v25, v46, s[56:59], s10 offen offset:1792
    buffer_load_dword v33, v46, s[56:59], s10 offen offset:2048
    buffer_load_dword v41, v46, s[56:59], s10 offen offset:2304
    s_add_u32 s10, s10, 2560
    ds_bpermute_b32 v128, v164, v148 offset:0
    ds_bpermute_b32 v129, v164, v148 offset:4
    ds_bpermute_b32 v130, v164, v148 offset:8
    ds_bpermute_b32 v131, v164, v148 offset:12
    ds_bpermute_b32 v132, v164, v148 offset:64
    ds_bpermute_b32 v133, v164, v148 offset:68
    ds_bpermute_b32 v134, v164, v148 offset:72
    ds_bpermute_b32 v135, v164, v148 offset:76
    ds_bpermute_b32 v136, v164, v149 offset:0
    ds_bpermute_b32 v137, v164, v149 offset:4
    ds_bpermute_b32 v138, v164, v149 offset:8
    ds_bpermute_b32 v139, v164, v149 offset:12
    ds_bpermute_b32 v140, v164, v149 offset:64
    ds_bpermute_b32 v141, v164, v149 offset:68
    ds_bpermute_b32 v142, v164, v149 offset:72
    ds_bpermute_b32 v143, v164, v149 offset:76
    ds_bpermute_b32 v144, v164, v150 offset:0
    ds_bpermute_b32 v145, v164, v150 offset:4
    ds_bpermute_b32 v146, v164, v150 offset:8
    ds_bpermute_b32 v147, v164, v150 offset:12
    s_waitcnt lgkmcnt(15)
    v_perm_b32 v128, v128, v128, v155
    v_perm_b32 v129, v129, v129, v155
    v_perm_b32 v130, v130, v130, v155
    v_perm_b32 v131, v131, v131, v155
    s_waitcnt lgkmcnt(12)
    v_perm_b32 v132, v132, v132, v155
    v_perm_b32 v133, v133, v133, v155
    v_perm_b32 v134, v134, v134, v155
    v_perm_b32 v135, v135, v135, v155
    s_waitcnt lgkmcnt(8)
    v_perm_b32 v136, v136, v136, v155
    v_perm_b32 v137, v137, v137, v155
    v_perm_b32 v138, v138, v138, v155
    v_perm_b32 v139, v139, v139, v155
    s_waitcnt lgkmcnt(4)
    v_perm_b32 v140, v140, v140, v155
    v_perm_b32 v141, v141, v141, v155
    v_perm_b32 v142, v142, v142, v155
    v_perm_b32 v143, v143, v143, v155
    s_waitcnt lgkmcnt(0)
    v_perm_b32 v144, v144, v144, v155
    v_perm_b32 v145, v145, v145, v155
    v_perm_b32 v146, v146, v146, v155
    v_perm_b32 v147, v147, v147, v155
    s_waitcnt vmcnt(63)
    v_mfma_f32_16x16x32_bf16 v[156:159], v[48:51], v[128:131], 0
    v_mfma_f32_16x16x32_bf16 v[160:163], v[88:91], v[128:131], 0
    s_waitcnt vmcnt(63)
    v_mfma_f32_16x16x32_bf16 v[156:159], v[52:55], v[132:135], v[156:159]
    v_mfma_f32_16x16x32_bf16 v[160:163], v[92:95], v[132:135], v[160:163]
    s_waitcnt vmcnt(63)
    v_mfma_f32_16x16x32_bf16 v[156:159], v[56:59], v[136:139], v[156:159]
    v_mfma_f32_16x16x32_bf16 v[160:163], v[96:99], v[136:139], v[160:163]
    s_waitcnt vmcnt(63)
    v_mfma_f32_16x16x32_bf16 v[156:159], v[60:63], v[140:143], v[156:159]
    v_mfma_f32_16x16x32_bf16 v[160:163], v[100:103], v[140:143], v[160:163]
    s_waitcnt vmcnt(63)
    v_mfma_f32_16x16x32_bf16 v[156:159], v[64:67], v[144:147], v[156:159]
    v_mfma_f32_16x16x32_bf16 v[160:163], v[104:107], v[144:147], v[160:163]
    ds_bpermute_b32 v128, v164, v150 offset:64
    ds_bpermute_b32 v129, v164, v150 offset:68
    ds_bpermute_b32 v130, v164, v150 offset:72
    ds_bpermute_b32 v131, v164, v150 offset:76
    ds_bpermute_b32 v132, v164, v151 offset:0
    ds_bpermute_b32 v133, v164, v151 offset:4
    ds_bpermute_b32 v134, v164, v151 offset:8
    ds_bpermute_b32 v135, v164, v151 offset:12
    ds_bpermute_b32 v136, v164, v151 offset:64
    ds_bpermute_b32 v137, v164, v151 offset:68
    ds_bpermute_b32 v138, v164, v151 offset:72
    ds_bpermute_b32 v139, v164, v151 offset:76
    ds_bpermute_b32 v140, v164, v152 offset:0
    ds_bpermute_b32 v141, v164, v152 offset:4
    ds_bpermute_b32 v142, v164, v152 offset:8
    ds_bpermute_b32 v143, v164, v152 offset:12
    ds_bpermute_b32 v144, v164, v152 offset:64
    ds_bpermute_b32 v145, v164, v152 offset:68
    ds_bpermute_b32 v146, v164, v152 offset:72
    ds_bpermute_b32 v147, v164, v152 offset:76
    s_waitcnt lgkmcnt(15)
    v_perm_b32 v128, v128, v128, v155
    v_perm_b32 v129, v129, v129, v155
    v_perm_b32 v130, v130, v130, v155
    v_perm_b32 v131, v131, v131, v155
    s_waitcnt lgkmcnt(12)
    v_perm_b32 v132, v132, v132, v155
    v_perm_b32 v133, v133, v133, v155
    v_perm_b32 v134, v134, v134, v155
    v_perm_b32 v135, v135, v135, v155
    s_waitcnt lgkmcnt(8)
    v_perm_b32 v136, v136, v136, v155
    v_perm_b32 v137, v137, v137, v155
    v_perm_b32 v138, v138, v138, v155
    v_perm_b32 v139, v139, v139, v155
    s_waitcnt lgkmcnt(4)
    v_perm_b32 v140, v140, v140, v155
    v_perm_b32 v141, v141, v141, v155
    v_perm_b32 v142, v142, v142, v155
    v_perm_b32 v143, v143, v143, v155
    s_waitcnt lgkmcnt(0)
    v_perm_b32 v144, v144, v144, v155
    v_perm_b32 v145, v145, v145, v155
    v_perm_b32 v146, v146, v146, v155
    v_perm_b32 v147, v147, v147, v155
    s_waitcnt vmcnt(63)
    v_mfma_f32_16x16x32_bf16 v[156:159], v[68:71], v[128:131], v[156:159]
    v_mfma_f32_16x16x32_bf16 v[160:163], v[108:111], v[128:131], v[160:163]
    s_waitcnt vmcnt(63)
    v_mfma_f32_16x16x32_bf16 v[156:159], v[72:75], v[132:135], v[156:159]
    v_mfma_f32_16x16x32_bf16 v[160:163], v[112:115], v[132:135], v[160:163]
    s_waitcnt vmcnt(56)
    v_mfma_f32_16x16x32_bf16 v[156:159], v[76:79], v[136:139], v[156:159]
    v_mfma_f32_16x16x32_bf16 v[160:163], v[116:119], v[136:139], v[160:163]
    s_waitcnt vmcnt(48)
    v_mfma_f32_16x16x32_bf16 v[156:159], v[80:83], v[140:143], v[156:159]
    v_mfma_f32_16x16x32_bf16 v[160:163], v[120:123], v[140:143], v[160:163]
    s_waitcnt vmcnt(40)
    v_mfma_f32_16x16x32_bf16 v[156:159], v[84:87], v[144:147], v[156:159]
    v_mfma_f32_16x16x32_bf16 v[160:163], v[124:127], v[144:147], v[160:163]
    s_mov_b32 s62, 0x0c0c0c0c
    s_mov_b32 s63, 0x0c0c0c0c
    s_mov_b32 s64, 0x30303030
    s_mov_b32 s65, 0x30303030
    s_mov_b32 s66, 0xc0c0c0c0
    s_mov_b32 s67, 0xc0c0c0c0
    s_and_b32 s9, s2, 7
    s_mul_i32 s9, s9, 2560
    s_add_u32 s9, s9, 8060928
    v_cndmask_b32 v156, v156, v157, s[62:63]
    v_cndmask_b32 v160, v160, v161, s[62:63]
    v_cndmask_b32 v156, v156, v158, s[64:65]
    v_cndmask_b32 v160, v160, v162, s[64:65]
    v_cndmask_b32 v156, v156, v159, s[66:67]
    v_cndmask_b32 v160, v160, v163, s[66:67]
    s_nop 0
    v_add_f32_dpp v156, v156, v156 quad_perm:[2,3,0,1] row_mask:0xf bank_mask:0xf
    v_add_f32_dpp v160, v160, v160 quad_perm:[2,3,0,1] row_mask:0xf bank_mask:0xf
    s_nop 0
    v_add_f32_dpp v156, v156, v156 row_ror:4 row_mask:0xf bank_mask:0xf
    v_add_f32_dpp v160, v160, v160 row_ror:4 row_mask:0xf bank_mask:0xf
    v_cvt_pk_bf16_f32 v160, v156, v160
    v_lshlrev_b32 v156, 16, v160
    v_and_b32 v160, v45, v160
    v_mul_f32 v157, 0xbfb8aa3b, v156
    v_exp_f32 v157, v157
    s_nop 0
    v_add_f32 v157, 1.0, v157
    v_rcp_f32 v157, v157
    s_nop 0
    v_mul_f32 v157, v157, v156
    v_cvt_pk_bf16_f32 v157, v157, v157
    v_lshlrev_b32 v157, 16, v157
    v_mul_f32 v157, v157, v160
    v_cvt_pk_bf16_f32 v157, v157, v157
    ds_bpermute_b32 v128, v167, v157 offset:0
    ds_bpermute_b32 v129, v167, v157 offset:4
    ds_bpermute_b32 v130, v167, v157 offset:64
    ds_bpermute_b32 v131, v167, v157 offset:68
    ds_bpermute_b32 v132, v167, v157 offset:128
    ds_bpermute_b32 v133, v167, v157 offset:132
    ds_bpermute_b32 v134, v167, v157 offset:192
    ds_bpermute_b32 v135, v167, v157 offset:196
    s_waitcnt lgkmcnt(7)
    v_and_b32 v128, v128, v165
    s_waitcnt lgkmcnt(6)
    v_and_b32 v129, v129, v165
    s_waitcnt lgkmcnt(5)
    v_and_b32 v130, v130, v165
    s_waitcnt lgkmcnt(4)
    v_and_b32 v131, v131, v165
    s_waitcnt lgkmcnt(3)
    v_and_b32 v132, v132, v165
    s_waitcnt lgkmcnt(2)
    v_and_b32 v133, v133, v165
    s_waitcnt lgkmcnt(1)
    v_and_b32 v134, v134, v165
    s_waitcnt lgkmcnt(0)
    v_and_b32 v135, v135, v165
    s_waitcnt vmcnt(0)
    s_nop 1
    v_mfma_f32_16x16x32_bf16 v[48:51], v[2:5], v[128:131], 0
    v_mfma_f32_16x16x32_bf16 v[52:55], v[10:13], v[128:131], 0
    v_mfma_f32_16x16x32_bf16 v[56:59], v[18:21], v[128:131], 0
    v_mfma_f32_16x16x32_bf16 v[60:63], v[26:29], v[128:131], 0
    v_mfma_f32_16x16x32_bf16 v[64:67], v[34:37], v[128:131], 0
    v_mfma_f32_16x16x32_bf16 v[48:51], v[6:9], v[132:135], v[48:51]
    v_mfma_f32_16x16x32_bf16 v[52:55], v[14:17], v[132:135], v[52:55]
    v_mfma_f32_16x16x32_bf16 v[56:59], v[22:25], v[132:135], v[56:59]
    v_mfma_f32_16x16x32_bf16 v[60:63], v[30:33], v[132:135], v[60:63]
    v_mfma_f32_16x16x32_bf16 v[64:67], v[38:41], v[132:135], v[64:67]
    s_mov_b32 exec_lo, 0x00ff00ff
    s_mov_b32 exec_hi, 0x00ff00ff
    s_nop 1
    buffer_atomic_add_f32 v48, v166, s[44:47], s9 offen offset:0
    buffer_atomic_add_f32 v49, v166, s[44:47], s9 offen offset:128
    buffer_atomic_add_f32 v50, v166, s[44:47], s9 offen offset:256
    buffer_atomic_add_f32 v51, v166, s[44:47], s9 offen offset:384
    buffer_atomic_add_f32 v52, v166, s[44:47], s9 offen offset:512
    buffer_atomic_add_f32 v53, v166, s[44:47], s9 offen offset:640
    buffer_atomic_add_f32 v54, v166, s[44:47], s9 offen offset:768
    buffer_atomic_add_f32 v55, v166, s[44:47], s9 offen offset:896
    buffer_atomic_add_f32 v56, v166, s[44:47], s9 offen offset:1024
    buffer_atomic_add_f32 v57, v166, s[44:47], s9 offen offset:1152
    buffer_atomic_add_f32 v58, v166, s[44:47], s9 offen offset:1280
    buffer_atomic_add_f32 v59, v166, s[44:47], s9 offen offset:1408
    buffer_atomic_add_f32 v60, v166, s[44:47], s9 offen offset:1536
    buffer_atomic_add_f32 v61, v166, s[44:47], s9 offen offset:1664
    buffer_atomic_add_f32 v62, v166, s[44:47], s9 offen offset:1792
    buffer_atomic_add_f32 v63, v166, s[44:47], s9 offen offset:1920
    buffer_atomic_add_f32 v64, v166, s[44:47], s9 offen offset:2048
    buffer_atomic_add_f32 v65, v166, s[44:47], s9 offen offset:2176
    buffer_atomic_add_f32 v66, v166, s[44:47], s9 offen offset:2304
    buffer_atomic_add_f32 v67, v166, s[44:47], s9 offen offset:2432
    s_mov_b64 exec, -1
    s_branch l2_kernel_tail
l2_kernel_dmaonly:
    s_barrier
    s_mov_b32 m0, 24576
    s_mov_b32 s14, 7888896
    buffer_load_dwordx4 v42, s[44:47], s14 offen lds
    s_mov_b32 m0, 25600
    s_mov_b32 s14, 7889920
    buffer_load_dwordx4 v42, s[44:47], s14 offen lds
    s_mov_b32 m0, 26624
    s_mov_b32 s14, 7890944
    buffer_load_dwordx4 v42, s[44:47], s14 offen lds
    s_mov_b32 m0, 27648
    s_mov_b32 s14, 7891968
    buffer_load_dwordx4 v42, s[44:47], s14 offen lds
    s_mov_b32 m0, 28672
    s_mov_b32 s14, 7892992
    buffer_load_dwordx4 v42, s[44:47], s14 offen lds
    s_mov_b32 m0, 29696
    s_mov_b32 s14, 7894016
    buffer_load_dwordx4 v42, s[44:47], s14 offen lds
    s_mov_b32 m0, 30720
    s_mov_b32 s14, 7895040
    buffer_load_dwordx4 v42, s[44:47], s14 offen lds
    s_mov_b32 m0, 31744
    s_mov_b32 s14, 7896064
    buffer_load_dwordx4 v42, s[44:47], s14 offen lds
    s_mov_b32 m0, 32768
    s_mov_b32 s14, 7897088
    buffer_load_dwordx4 v42, s[44:47], s14 offen lds
    s_mov_b32 m0, 33792
    s_mov_b32 s14, 7898112
    buffer_load_dwordx4 v42, s[44:47], s14 offen lds
    s_mov_b32 m0, 34816
    s_mov_b32 s14, 7899136
    buffer_load_dwordx4 v42, s[44:47], s14 offen lds
    s_mov_b32 m0, 35840
    s_mov_b32 s14, 7900160
    buffer_load_dwordx4 v42, s[44:47], s14 offen lds
    s_mov_b32 m0, 36864
    s_mov_b32 s14, 7901184
    buffer_load_dwordx4 v42, s[44:47], s14 offen lds
    s_mov_b32 m0, 37888
    s_mov_b32 s14, 7902208
    buffer_load_dwordx4 v42, s[44:47], s14 offen lds
    s_mov_b32 m0, 38912
    s_mov_b32 s14, 7903232
    buffer_load_dwordx4 v42, s[44:47], s14 offen lds
    s_mov_b32 m0, 39936
    s_mov_b32 s14, 7904256
    buffer_load_dwordx4 v42, s[44:47], s14 offen lds
    s_mov_b32 m0, 40960
    s_mov_b32 s14, 7905280
    buffer_load_dwordx4 v42, s[44:47], s14 offen lds
    s_mov_b32 m0, 41984
    s_mov_b32 s14, 7906304
    buffer_load_dwordx4 v42, s[44:47], s14 offen lds
    s_mov_b32 m0, 43008
    s_mov_b32 s14, 7907328
    buffer_load_dwordx4 v42, s[44:47], s14 offen lds
    s_mov_b32 m0, 44032
    s_mov_b32 s14, 7908352
    buffer_load_dwordx4 v42, s[44:47], s14 offen lds
    s_mov_b32 m0, 45056
    s_mov_b32 s14, 7909376
    buffer_load_dwordx4 v42, s[44:47], s14 offen lds
    s_mov_b32 m0, 46080
    s_mov_b32 s14, 7910400
    buffer_load_dwordx4 v42, s[44:47], s14 offen lds
    s_mov_b32 m0, 47104
    s_mov_b32 s14, 7911424
    buffer_load_dwordx4 v42, s[44:47], s14 offen lds
    s_mov_b32 m0, 48128
    s_mov_b32 s14, 7912448
    buffer_load_dwordx4 v42, s[44:47], s14 offen lds
    s_mov_b32 m0, 49152
    s_mov_b32 s14, 7913472
    buffer_load_dwordx4 v42, s[44:47], s14 offen lds
    s_mov_b32 m0, 50176
    s_mov_b32 s14, 7914496
    buffer_load_dwordx4 v42, s[44:47], s14 offen lds
    s_mov_b32 m0, 51200
    s_mov_b32 s14, 7915520
    buffer_load_dwordx4 v42, s[44:47], s14 offen lds
    s_mov_b32 m0, 52224
    s_mov_b32 s14, 7916544
    buffer_load_dwordx4 v42, s[44:47], s14 offen lds
    s_mov_b32 m0, 53248
    s_mov_b32 s14, 7917568
    buffer_load_dwordx4 v42, s[44:47], s14 offen lds
    s_mov_b32 m0, 54272
    s_mov_b32 s14, 7918592
    buffer_load_dwordx4 v42, s[44:47], s14 offen lds
    s_mov_b32 m0, 55296
    s_mov_b32 s14, 7919616
    buffer_load_dwordx4 v42, s[44:47], s14 offen lds
    s_mov_b32 m0, 56320
    s_mov_b32 s14, 7920640
    buffer_load_dwordx4 v42, s[44:47], s14 offen lds
    s_mov_b32 m0, 57344
    s_mov_b32 s14, 7921664
    buffer_load_dwordx4 v42, s[44:47], s14 offen lds
    s_mov_b32 m0, 58368
    s_mov_b32 s14, 7922688
    buffer_load_dwordx4 v42, s[44:47], s14 offen lds
    s_mov_b32 m0, 59392
    s_mov_b32 s14, 7923712
    buffer_load_dwordx4 v42, s[44:47], s14 offen lds
    s_mov_b32 m0, 60416
    s_mov_b32 s14, 7924736
    buffer_load_dwordx4 v42, s[44:47], s14 offen lds
    s_mov_b32 m0, 61440
    s_mov_b32 s14, 7925760
    buffer_load_dwordx4 v42, s[44:47], s14 offen lds
    s_mov_b32 m0, 62464
    s_mov_b32 s14, 7926784
    buffer_load_dwordx4 v42, s[44:47], s14 offen lds
    s_mov_b32 m0, 63488
    s_mov_b32 s14, 7927808
    buffer_load_dwordx4 v42, s[44:47], s14 offen lds
    s_mov_b32 m0, 64512
    s_mov_b32 s14, 7928832
    buffer_load_dwordx4 v42, s[44:47], s14 offen lds
    s_mov_b32 m0, 65536
    s_mov_b32 s14, 7929856
    buffer_load_dwordx4 v42, s[44:47], s14 offen lds
    s_mov_b32 m0, 66560
    s_mov_b32 s14, 7930880
    buffer_load_dwordx4 v42, s[44:47], s14 offen lds
    s_mov_b32 m0, 67584
    s_mov_b32 s14, 7931904
    buffer_load_dwordx4 v42, s[44:47], s14 offen lds
    s_mov_b32 m0, 68608
    s_mov_b32 s14, 7932928
    buffer_load_dwordx4 v42, s[44:47], s14 offen lds
    s_mov_b32 m0, 69632
    s_mov_b32 s14, 7933952
    buffer_load_dwordx4 v42, s[44:47], s14 offen lds
    s_mov_b32 m0, 70656
    s_mov_b32 s14, 7934976
    buffer_load_dwordx4 v42, s[44:47], s14 offen lds
    s_mov_b32 m0, 71680
    s_mov_b32 s14, 7936000
    buffer_load_dwordx4 v42, s[44:47], s14 offen lds
    s_mov_b32 m0, 72704
    s_mov_b32 s14, 7937024
    buffer_load_dwordx4 v42, s[44:47], s14 offen lds
    s_mov_b32 m0, 73728
    s_mov_b32 s14, 7938048
    buffer_load_dwordx4 v42, s[44:47], s14 offen lds
    s_mov_b32 m0, 74752
    s_mov_b32 s14, 7939072
    buffer_load_dwordx4 v42, s[44:47], s14 offen lds
    s_mov_b32 m0, 75776
    s_mov_b32 s14, 7940096
    buffer_load_dwordx4 v42, s[44:47], s14 offen lds
    s_mov_b32 m0, 76800
    s_mov_b32 s14, 7941120
    buffer_load_dwordx4 v42, s[44:47], s14 offen lds
    s_mov_b32 m0, 77824
    s_mov_b32 s14, 7942144
    buffer_load_dwordx4 v42, s[44:47], s14 offen lds
    s_mov_b32 m0, 78848
    s_mov_b32 s14, 7943168
    buffer_load_dwordx4 v42, s[44:47], s14 offen lds
    s_mov_b32 m0, 79872
    s_mov_b32 s14, 7944192
    buffer_load_dwordx4 v42, s[44:47], s14 offen lds
    s_mov_b32 m0, 80896
    s_mov_b32 s14, 7945216
    buffer_load_dwordx4 v42, s[44:47], s14 offen lds
    s_mov_b32 m0, 81920
    s_mov_b32 s14, 7946240
    buffer_load_dwordx4 v42, s[44:47], s14 offen lds
    s_mov_b32 m0, 82944
    s_mov_b32 s14, 7947264
    buffer_load_dwordx4 v42, s[44:47], s14 offen lds
    s_mov_b32 m0, 83968
    s_mov_b32 s14, 7948288
    buffer_load_dwordx4 v42, s[44:47], s14 offen lds
    s_mov_b32 m0, 84992
    s_mov_b32 s14, 7949312
    buffer_load_dwordx4 v42, s[44:47], s14 offen lds
    s_mov_b32 m0, 86016
    s_mov_b32 s14, 7950336
    buffer_load_dwordx4 v42, s[44:47], s14 offen lds
    s_mov_b32 m0, 87040
    s_mov_b32 s14, 7951360
    buffer_load_dwordx4 v42, s[44:47], s14 offen lds
    s_mov_b32 m0, 88064
    s_mov_b32 s14, 7952384
    buffer_load_dwordx4 v42, s[44:47], s14 offen lds
    s_mov_b32 m0, 89088
    s_mov_b32 s14, 7953408
    buffer_load_dwordx4 v42, s[44:47], s14 offen lds
    s_mov_b32 m0, 90112
    s_mov_b32 s14, 7954432
    buffer_load_dwordx4 v42, s[44:47], s14 offen lds
    s_mov_b32 m0, 91136
    s_mov_b32 s14, 7955456
    buffer_load_dwordx4 v42, s[44:47], s14 offen lds
    s_mov_b32 m0, 92160
    s_mov_b32 s14, 7956480
    buffer_load_dwordx4 v42, s[44:47], s14 offen lds
    s_mov_b32 m0, 93184
    s_mov_b32 s14, 7957504
    buffer_load_dwordx4 v42, s[44:47], s14 offen lds
    s_mov_b32 m0, 94208
    s_mov_b32 s14, 7958528
    buffer_load_dwordx4 v42, s[44:47], s14 offen lds
    s_mov_b32 m0, 95232
    s_mov_b32 s14, 7959552
    buffer_load_dwordx4 v42, s[44:47], s14 offen lds
    s_mov_b32 m0, 96256
    s_mov_b32 s14, 7960576
    buffer_load_dwordx4 v42, s[44:47], s14 offen lds
    s_mov_b32 m0, 97280
    s_mov_b32 s14, 7961600
    buffer_load_dwordx4 v42, s[44:47], s14 offen lds
    s_mov_b32 m0, 98304
    s_mov_b32 s14, 7962624
    buffer_load_dwordx4 v42, s[44:47], s14 offen lds
    s_mov_b32 m0, 99328
    s_mov_b32 s14, 7963648
    buffer_load_dwordx4 v42, s[44:47], s14 offen lds
    s_mov_b32 m0, 100352
    s_mov_b32 s14, 7964672
    buffer_load_dwordx4 v42, s[44:47], s14 offen lds
    s_mov_b32 m0, 101376
    s_mov_b32 s14, 7965696
    buffer_load_dwordx4 v42, s[44:47], s14 offen lds
    s_mov_b32 m0, 102400
    s_mov_b32 s14, 7966720
    buffer_load_dwordx4 v42, s[44:47], s14 offen lds
    s_mov_b32 m0, 103424
    s_mov_b32 s14, 7967744
    buffer_load_dwordx4 v42, s[44:47], s14 offen lds
    s_mov_b32 m0, 104448
    s_mov_b32 s14, 7968768
    buffer_load_dwordx4 v42, s[44:47], s14 offen lds
    s_mov_b32 m0, 105472
    s_mov_b32 s14, 7969792
    buffer_load_dwordx4 v42, s[44:47], s14 offen lds
    s_waitcnt vmcnt(48)
    s_barrier
    s_mov_b32 m0, 106496
    s_mov_b32 s14, 7970816
    buffer_load_dwordx4 v42, s[44:47], s14 offen lds
    s_mov_b32 m0, 107520
    s_mov_b32 s14, 7971840
    buffer_load_dwordx4 v42, s[44:47], s14 offen lds
    s_mov_b32 m0, 108544
    s_mov_b32 s14, 7972864
    buffer_load_dwordx4 v42, s[44:47], s14 offen lds
    s_mov_b32 m0, 109568
    s_mov_b32 s14, 7973888
    buffer_load_dwordx4 v42, s[44:47], s14 offen lds
    s_mov_b32 m0, 110592
    s_mov_b32 s14, 7974912
    buffer_load_dwordx4 v42, s[44:47], s14 offen lds
    s_mov_b32 m0, 111616
    s_mov_b32 s14, 7975936
    buffer_load_dwordx4 v42, s[44:47], s14 offen lds
    s_mov_b32 m0, 112640
    s_mov_b32 s14, 7976960
    buffer_load_dwordx4 v42, s[44:47], s14 offen lds
    s_mov_b32 m0, 113664
    s_mov_b32 s14, 7977984
    buffer_load_dwordx4 v42, s[44:47], s14 offen lds
    s_mov_b32 m0, 114688
    s_mov_b32 s14, 7979008
    buffer_load_dwordx4 v42, s[44:47], s14 offen lds
    s_mov_b32 m0, 115712
    s_mov_b32 s14, 7980032
    buffer_load_dwordx4 v42, s[44:47], s14 offen lds
    s_mov_b32 m0, 116736
    s_mov_b32 s14, 7981056
    buffer_load_dwordx4 v42, s[44:47], s14 offen lds
    s_mov_b32 m0, 117760
    s_mov_b32 s14, 7982080
    buffer_load_dwordx4 v42, s[44:47], s14 offen lds
    s_mov_b32 m0, 118784
    s_mov_b32 s14, 7983104
    buffer_load_dwordx4 v42, s[44:47], s14 offen lds
    s_mov_b32 m0, 119808
    s_mov_b32 s14, 7984128
    buffer_load_dwordx4 v42, s[44:47], s14 offen lds
    s_mov_b32 m0, 120832
    s_mov_b32 s14, 7985152
    buffer_load_dwordx4 v42, s[44:47], s14 offen lds
    s_mov_b32 m0, 121856
    s_mov_b32 s14, 7986176
    buffer_load_dwordx4 v42, s[44:47], s14 offen lds
    s_mov_b32 m0, 122880
    s_mov_b32 s14, 7987200
    buffer_load_dwordx4 v42, s[44:47], s14 offen lds
    s_mov_b32 m0, 123904
    s_mov_b32 s14, 7988224
    buffer_load_dwordx4 v42, s[44:47], s14 offen lds
    s_mov_b32 m0, 124928
    s_mov_b32 s14, 7989248
    buffer_load_dwordx4 v42, s[44:47], s14 offen lds
    s_mov_b32 m0, 125952
    s_mov_b32 s14, 7990272
    buffer_load_dwordx4 v42, s[44:47], s14 offen lds
    s_mov_b32 m0, 126976
    s_mov_b32 s14, 7991296
    buffer_load_dwordx4 v42, s[44:47], s14 offen lds
    s_mov_b32 m0, 128000
    s_mov_b32 s14, 7992320
    buffer_load_dwordx4 v42, s[44:47], s14 offen lds
    s_mov_b32 m0, 129024
    s_mov_b32 s14, 7993344
    buffer_load_dwordx4 v42, s[44:47], s14 offen lds
    s_mov_b32 m0, 130048
    s_mov_b32 s14, 7994368
    buffer_load_dwordx4 v42, s[44:47], s14 offen lds
    s_mov_b32 m0, 131072
    s_mov_b32 s14, 7995392
    buffer_load_dwordx4 v42, s[44:47], s14 offen lds
    s_mov_b32 m0, 132096
    s_mov_b32 s14, 7996416
    buffer_load_dwordx4 v42, s[44:47], s14 offen lds
    s_mov_b32 m0, 133120
    s_mov_b32 s14, 7997440
    buffer_load_dwordx4 v42, s[44:47], s14 offen lds
    s_mov_b32 m0, 134144
    s_mov_b32 s14, 7998464
    buffer_load_dwordx4 v42, s[44:47], s14 offen lds
    s_mov_b32 m0, 135168
    s_mov_b32 s14, 7999488
    buffer_load_dwordx4 v42, s[44:47], s14 offen lds
    s_mov_b32 m0, 136192
    s_mov_b32 s14, 8000512
    buffer_load_dwordx4 v42, s[44:47], s14 offen lds
    s_mov_b32 m0, 137216
    s_mov_b32 s14, 8001536
    buffer_load_dwordx4 v42, s[44:47], s14 offen lds
    s_mov_b32 m0, 138240
    s_mov_b32 s14, 8002560
    buffer_load_dwordx4 v42, s[44:47], s14 offen lds
    s_mov_b32 m0, 139264
    s_mov_b32 s14, 8003584
    buffer_load_dwordx4 v42, s[44:47], s14 offen lds
    s_mov_b32 m0, 140288
    s_mov_b32 s14, 8004608
    buffer_load_dwordx4 v42, s[44:47], s14 offen lds
    s_mov_b32 m0, 141312
    s_mov_b32 s14, 8005632
    buffer_load_dwordx4 v42, s[44:47], s14 offen lds
    s_mov_b32 m0, 142336
    s_mov_b32 s14, 8006656
    buffer_load_dwordx4 v42, s[44:47], s14 offen lds
    s_mov_b32 m0, 143360
    s_mov_b32 s14, 8007680
    buffer_load_dwordx4 v42, s[44:47], s14 offen lds
    s_mov_b32 m0, 144384
    s_mov_b32 s14, 8008704
    buffer_load_dwordx4 v42, s[44:47], s14 offen lds
    s_mov_b32 m0, 145408
    s_mov_b32 s14, 8009728
    buffer_load_dwordx4 v42, s[44:47], s14 offen lds
    s_mov_b32 m0, 146432
    s_mov_b32 s14, 8010752
    buffer_load_dwordx4 v42, s[44:47], s14 offen lds
    s_mov_b32 m0, 147456
    s_mov_b32 s14, 8011776
    buffer_load_dwordx4 v42, s[44:47], s14 offen lds
    s_mov_b32 m0, 148480
    s_mov_b32 s14, 8012800
    buffer_load_dwordx4 v42, s[44:47], s14 offen lds
    s_mov_b32 m0, 149504
    s_mov_b32 s14, 8013824
    buffer_load_dwordx4 v42, s[44:47], s14 offen lds
    s_mov_b32 m0, 150528
    s_mov_b32 s14, 8014848
    buffer_load_dwordx4 v42, s[44:47], s14 offen lds
    s_mov_b32 m0, 151552
    s_mov_b32 s14, 8015872
    buffer_load_dwordx4 v42, s[44:47], s14 offen lds
    s_mov_b32 m0, 152576
    s_mov_b32 s14, 8016896
    buffer_load_dwordx4 v42, s[44:47], s14 offen lds
    s_mov_b32 m0, 153600
    s_mov_b32 s14, 8017920
    buffer_load_dwordx4 v42, s[44:47], s14 offen lds
    s_mov_b32 m0, 154624
    s_mov_b32 s14, 8018944
    buffer_load_dwordx4 v42, s[44:47], s14 offen lds
    s_mov_b32 m0, 155648
    s_mov_b32 s14, 8019968
    buffer_load_dwordx4 v42, s[44:47], s14 offen lds
    s_mov_b32 m0, 156672
    s_mov_b32 s14, 8020992
    buffer_load_dwordx4 v42, s[44:47], s14 offen lds
    s_mov_b32 m0, 157696
    s_mov_b32 s14, 8022016
    buffer_load_dwordx4 v42, s[44:47], s14 offen lds
    s_mov_b32 m0, 158720
    s_mov_b32 s14, 8023040
    buffer_load_dwordx4 v42, s[44:47], s14 offen lds
    s_mov_b32 m0, 159744
    s_mov_b32 s14, 8024064
    buffer_load_dwordx4 v42, s[44:47], s14 offen lds
    s_mov_b32 m0, 160768
    s_mov_b32 s14, 8025088
    buffer_load_dwordx4 v42, s[44:47], s14 offen lds
    s_mov_b32 m0, 161792
    s_mov_b32 s14, 8026112
    buffer_load_dwordx4 v42, s[44:47], s14 offen lds
    s_mov_b32 m0, 162816
    s_mov_b32 s14, 8027136
    buffer_load_dwordx4 v42, s[44:47], s14 offen lds
    s_waitcnt vmcnt(0)
    s_barrier
    s_branch l2_kernel_pf
l2_kernel_tail:
    s_cmp_lg_u32 s2, 0
    s_cbranch_scc1 l2_kernel_pf
    s_and_b32 s11, s11, 0xffff0000
    s_not_b32 s10, s11
    s_and_b32 s10, s10, 0xffff0000
    s_and_b32 s9, s11, 0x7fff0000
    s_bitcmp1_b32 s11, 31
    s_cselect_b32 s9, s9, s10
    v_mov_b32 v3, 0xbfb8aa3b
    v_mul_f32 v3, s9, v3
    v_exp_f32 v3, v3
    v_mov_b32 v2, s6
    v_add_f32 v3, 1.0, v3
    v_rcp_f32 v3, v3
    v_mov_b32 v4, 0
    v_cvt_pk_bf16_f32 v3, v3, v3
    v_lshlrev_b32 v3, 16, v3
    s_mov_b32 s9, 8650752
    s_mov_b64 exec, 1
    buffer_store_dwordx2 v[2:3], v4, s[44:47], s9 offen
    s_mov_b64 exec, -1
l2_kernel_pf:
    s_lshr_b32 s9, s2, 3
    v_lshlrev_b32 v42, 4, v0
    s_getpc_b64 s[62:63]
l2_kernel_pc:
    s_add_u32 s62, s62, l3_kernel-l2_kernel_pc
    s_addc_u32 s63, s63, 0
    s_and_b32 s10, s9, 7
    s_lshl_b32 s10, s10, 10
    v_add_u32 v43, s10, v42
    v_min_u32 v43, l3_kernel_end-l3_kernel-12, v43
    global_load_dwordx4 v[44:47], v43, s[62:63]
    s_mov_b32 s60, s24
    s_and_b32 s61, s25, 0xffff
    s_mov_b32 s62, 819200
    s_mov_b32 s63, 0x00020000
    s_mul_i32 s9, s9, 25600
    buffer_load_dwordx4 v[48:51], v42, s[60:63], s9 offen offset:0
    buffer_load_dwordx4 v[52:55], v42, s[60:63], s9 offen offset:1024
    buffer_load_dwordx4 v[56:59], v42, s[60:63], s9 offen offset:2048
    buffer_load_dwordx4 v[60:63], v42, s[60:63], s9 offen offset:3072
    s_add_u32 s9, s9, 4096
    buffer_load_dwordx4 v[64:67], v42, s[60:63], s9 offen offset:0
    buffer_load_dwordx4 v[68:71], v42, s[60:63], s9 offen offset:1024
    buffer_load_dwordx4 v[72:75], v42, s[60:63], s9 offen offset:2048
    buffer_load_dwordx4 v[76:79], v42, s[60:63], s9 offen offset:3072
    s_add_u32 s9, s9, 4096
    buffer_load_dwordx4 v[80:83], v42, s[60:63], s9 offen offset:0
    buffer_load_dwordx4 v[84:87], v42, s[60:63], s9 offen offset:1024
    buffer_load_dwordx4 v[88:91], v42, s[60:63], s9 offen offset:2048
    buffer_load_dwordx4 v[92:95], v42, s[60:63], s9 offen offset:3072
    s_add_u32 s9, s9, 4096
    buffer_load_dwordx4 v[96:99], v42, s[60:63], s9 offen offset:0
    buffer_load_dwordx4 v[100:103], v42, s[60:63], s9 offen offset:1024
    buffer_load_dwordx4 v[104:107], v42, s[60:63], s9 offen offset:2048
    buffer_load_dwordx4 v[108:111], v42, s[60:63], s9 offen offset:3072
    s_add_u32 s9, s9, 4096
    buffer_load_dwordx4 v[112:115], v42, s[60:63], s9 offen offset:0
    buffer_load_dwordx4 v[116:119], v42, s[60:63], s9 offen offset:1024
    buffer_load_dwordx4 v[120:123], v42, s[60:63], s9 offen offset:2048
    buffer_load_dwordx4 v[124:127], v42, s[60:63], s9 offen offset:3072
    s_add_u32 s9, s9, 4096
    buffer_load_dwordx4 v[128:131], v42, s[60:63], s9 offen offset:0
    buffer_load_dwordx4 v[132:135], v42, s[60:63], s9 offen offset:1024
    buffer_load_dwordx4 v[136:139], v42, s[60:63], s9 offen offset:2048
    buffer_load_dwordx4 v[140:143], v42, s[60:63], s9 offen offset:3072
    s_add_u32 s9, s9, 4096
    buffer_load_dwordx4 v[144:147], v42, s[60:63], s9 offen offset:0
    s_waitcnt vmcnt(0)
l2_kernel_end:
    s_endpgm
.globl l3_kernel
.p2align 8
.type l3_kernel,@function
l3_kernel:
    s_cmp_ge_u32 s2, 256
    s_cbranch_scc1 l3_kernel_end
    s_load_dwordx16 s[16:31], s[0:1], 0
    s_load_dwordx8 s[32:39], s[0:1], 64
    s_load_dwordx2 s[40:41], s[0:1], 96
    v_lshrrev_b32 v1, 6, v0
    v_and_b32 v0, 63, v0
    s_and_b32 s4, s2, 7
    v_readfirstlane_b32 s3, v1
    s_lshr_b32 s5, s2, 3
    s_lshl_b32 s4, s4, 2
    s_lshr_b32 s6, s5, 3
    s_add_u32 s4, s4, s6
    s_and_b32 s5, s5, 7
    v_lshlrev_b32 v197, 4, v0
    v_and_b32 v5, 3, v0
    v_lshrrev_b32 v4, 2, v0
    v_mul_u32_u24 v6, 160, v4
    v_mad_u32_u24 v198, v5, 40, v6
    v_add_u32 v199, 61440, v198
    v_add_u32 v4, 0, v0
    v_mul_u32_u24 v5, 6554, v4
    v_lshrrev_b32 v5, 16, v5
    v_mul_u32_u24 v6, 10, v5
    v_sub_u32 v6, v4, v6
    v_bfe_u32 v7, v5, 2, 2
    v_lshrrev_b32 v8, 4, v5
    v_and_b32 v9, 3, v5
    v_mad_u32_u24 v9, v7, 40, v9
    v_mad_u32_u24 v9, v8, 20, v9
    v_mul_u32_u24 v9, 1280, v9
    v_lshl_add_u32 v192, v6, 4, v9
    v_mul_u32_u24 v9, 1280, v5
    v_lshl_add_u32 v246, v6, 4, v9
    v_lshlrev_b32 v249, 3, v5
    v_add_u32 v4, 64, v0
    v_mul_u32_u24 v5, 6554, v4
    v_lshrrev_b32 v5, 16, v5
    v_mul_u32_u24 v6, 10, v5
    v_sub_u32 v6, v4, v6
    v_bfe_u32 v7, v5, 2, 2
    v_lshrrev_b32 v8, 4, v5
    v_and_b32 v9, 3, v5
    v_mad_u32_u24 v9, v7, 40, v9
    v_mad_u32_u24 v9, v8, 20, v9
    v_mul_u32_u24 v9, 1280, v9
    v_lshl_add_u32 v193, v6, 4, v9
    v_mul_u32_u24 v9, 1280, v5
    v_lshl_add_u32 v247, v6, 4, v9
    v_lshlrev_b32 v250, 3, v5
    v_add_u32 v4, 128, v0
    v_mul_u32_u24 v5, 6554, v4
    v_lshrrev_b32 v5, 16, v5
    v_mul_u32_u24 v6, 10, v5
    v_sub_u32 v6, v4, v6
    v_bfe_u32 v7, v5, 2, 2
    v_lshrrev_b32 v8, 4, v5
    v_and_b32 v9, 3, v5
    v_mad_u32_u24 v9, v7, 40, v9
    v_mad_u32_u24 v9, v8, 20, v9
    v_mul_u32_u24 v9, 1280, v9
    v_lshl_add_u32 v194, v6, 4, v9
    v_mul_u32_u24 v9, 1280, v5
    v_lshl_add_u32 v248, v6, 4, v9
    v_lshlrev_b32 v251, 3, v5
    v_add_u32 v4, 192, v0
    v_mul_u32_u24 v5, 6554, v4
    v_lshrrev_b32 v5, 16, v5
    v_mul_u32_u24 v6, 10, v5
    v_sub_u32 v6, v4, v6
    v_bfe_u32 v7, v5, 2, 2
    v_lshrrev_b32 v8, 4, v5
    v_and_b32 v9, 3, v5
    v_mad_u32_u24 v9, v7, 40, v9
    v_mad_u32_u24 v9, v8, 20, v9
    v_mul_u32_u24 v9, 1280, v9
    v_lshl_add_u32 v195, v6, 4, v9
    v_add_u32 v4, 256, v0
    v_mul_u32_u24 v5, 6554, v4
    v_lshrrev_b32 v5, 16, v5
    v_mul_u32_u24 v6, 10, v5
    v_sub_u32 v6, v4, v6
    v_bfe_u32 v7, v5, 2, 2
    v_lshrrev_b32 v8, 4, v5
    v_and_b32 v9, 3, v5
    v_mad_u32_u24 v9, v7, 40, v9
    v_mad_u32_u24 v9, v8, 20, v9
    v_mul_u32_u24 v9, 1280, v9
    v_lshl_add_u32 v196, v6, 4, v9
    s_lshl_b32 s7, s4, 6
    s_lshl_b32 s8, s3, 4
    s_add_u32 s7, s7, s8
    s_mul_i32 s6, s7, 1280
    s_mul_i32 s8, s3, 204800
    s_mul_i32 s9, s5, 160
    s_add_u32 s8, s8, s9
    s_mul_i32 s11, s3, 5120
    s_add_u32 s64, s4, s5
    s_mul_i32 s10, s64, 52
    s_lshr_b32 s10, s10, 8
    s_mul_i32 s10, s10, 5
    s_sub_u32 s64, s64, s10
    s_add_u32 s65, s64, 1
    s_cmp_eq_u32 s65, 5
    s_cselect_b32 s65, 0, s65
    s_add_u32 s66, s65, 1
    s_cmp_eq_u32 s66, 5
    s_cselect_b32 s66, 0, s66
    s_add_u32 s67, s66, 1
    s_cmp_eq_u32 s67, 5
    s_cselect_b32 s67, 0, s67
    s_add_u32 s68, s67, 1
    s_cmp_eq_u32 s68, 5
    s_cselect_b32 s68, 0, s68
    s_waitcnt lgkmcnt(0)
    s_mov_b32 s44, s16
    s_and_b32 s45, s17, 0xffff
    s_mov_b32 s46, 2621440
    s_mov_b32 s47, 0x00020000
    s_mov_b32 s48, s24
    s_and_b32 s49, s25, 0xffff
    s_mov_b32 s50, 819200
    s_mov_b32 s51, 0x00020000
    s_mov_b32 s52, s40
    s_and_b32 s53, s41, 0xffff
    s_mov_b32 s54, 9437184
    s_mov_b32 s55, 0x00020000
    s_add_u32 s10, s6, s9
    s_add_u32 s12, s40, 8650752
    s_addc_u32 s13, s41, 0
    s_load_dwordx2 s[14:15], s[12:13], 0
    s_lshl_b32 s9, s7, 3
    s_add_u32 s9, s9, 5242880
    s_mul_i32 s6, s7, 1280
    s_add_u32 s6, s6, 2621440
    buffer_load_dwordx4 v[228:231], v246, s[44:47], s10 offen
    buffer_load_dwordx2 v[240:241], v249, s[52:55], s9 offen
    buffer_load_dwordx4 v[232:235], v247, s[44:47], s10 offen
    buffer_load_dwordx2 v[242:243], v250, s[52:55], s9 offen
    s_mov_b32 exec_hi, 0
    buffer_load_dwordx4 v[236:239], v248, s[44:47], s10 offen
    buffer_load_dwordx2 v[244:245], v251, s[52:55], s9 offen
    s_mov_b32 exec_hi, -1
    s_lshl_b32 s12, s64, 12
    s_mul_i32 s13, s64, 5120
    s_add_u32 s12, s12, s6
    s_add_u32 s13, s13, s8
    buffer_load_dwordx4 v[16:19], v197, s[52:55], s12 offen offset:0
    buffer_load_dwordx4 v[20:23], v197, s[52:55], s12 offen offset:1024
    buffer_load_dwordx4 v[24:27], v197, s[52:55], s12 offen offset:2048
    buffer_load_dwordx4 v[28:31], v197, s[52:55], s12 offen offset:3072
    s_add_u32 m0, s11, 0
    s_nop 0
    buffer_load_dwordx4 v192, s[48:51], s13 offen lds
    s_add_u32 m0, s11, 1024
    s_nop 0
    buffer_load_dwordx4 v193, s[48:51], s13 offen lds
    s_add_u32 m0, s11, 2048
    s_nop 0
    buffer_load_dwordx4 v194, s[48:51], s13 offen lds
    s_add_u32 m0, s11, 3072
    s_nop 0
    buffer_load_dwordx4 v195, s[48:51], s13 offen lds
    s_add_u32 m0, s11, 4096
    s_nop 0
    buffer_load_dwordx4 v196, s[48:51], s13 offen lds
    s_lshl_b32 s12, s65, 12
    s_mul_i32 s13, s65, 5120
    s_add_u32 s12, s12, s6
    s_add_u32 s13, s13, s8
    buffer_load_dwordx4 v[32:35], v197, s[52:55], s12 offen offset:0
    buffer_load_dwordx4 v[36:39], v197, s[52:55], s12 offen offset:1024
    buffer_load_dwordx4 v[40:43], v197, s[52:55], s12 offen offset:2048
    buffer_load_dwordx4 v[44:47], v197, s[52:55], s12 offen offset:3072
    s_add_u32 m0, s11, 20480
    s_nop 0
    buffer_load_dwordx4 v192, s[48:51], s13 offen lds
    s_add_u32 m0, s11, 21504
    s_nop 0
    buffer_load_dwordx4 v193, s[48:51], s13 offen lds
    s_add_u32 m0, s11, 22528
    s_nop 0
    buffer_load_dwordx4 v194, s[48:51], s13 offen lds
    s_add_u32 m0, s11, 23552
    s_nop 0
    buffer_load_dwordx4 v195, s[48:51], s13 offen lds
    s_add_u32 m0, s11, 24576
    s_nop 0
    buffer_load_dwordx4 v196, s[48:51], s13 offen lds
    s_waitcnt lgkmcnt(0)
    s_lshr_b32 s12, s14, 4
    s_lshl_b32 s13, s4, 2
    s_add_u32 s13, s13, s3
    s_cmp_lg_u32 s12, s13
    s_cbranch_scc1 l3_kernel_noyl
    s_and_b32 s12, s14, 15
    s_mul_i32 s12, s12, 10
    v_subrev_u32 v5, s12, v0
    v_and_b32 v5, 63, v5
    s_mul_i32 s13, s5, 10
    v_cmp_gt_u32 vcc, 10, v5
    v_add_u32 v5, s13, v5
    v_lshrrev_b32 v6, 4, v5
    v_and_b32 v7, 3, v5
    v_bfe_u32 v5, v5, 2, 2
    v_lshlrev_b32 v6, 9, v6
    v_lshl_add_u32 v6, v7, 5, v6
    v_lshl_add_u32 v7, v5, 3, v6
    s_mov_b32 s12, 8060928
    s_and_saveexec_b64 s[42:43], vcc
    buffer_load_dwordx2 v[96:97], v7, s[52:55], s12 offen offset:0
    buffer_load_dwordx2 v[98:99], v7, s[52:55], s12 offen offset:128
    buffer_load_dwordx2 v[100:101], v7, s[52:55], s12 offen offset:256
    buffer_load_dwordx2 v[102:103], v7, s[52:55], s12 offen offset:384
    buffer_load_dwordx2 v[104:105], v7, s[52:55], s12 offen offset:2560
    buffer_load_dwordx2 v[106:107], v7, s[52:55], s12 offen offset:2688
    buffer_load_dwordx2 v[108:109], v7, s[52:55], s12 offen offset:2816
    buffer_load_dwordx2 v[110:111], v7, s[52:55], s12 offen offset:2944
    s_add_u32 s12, s12, 5120
    buffer_load_dwordx2 v[112:113], v7, s[52:55], s12 offen offset:0
    buffer_load_dwordx2 v[114:115], v7, s[52:55], s12 offen offset:128
    buffer_load_dwordx2 v[116:117], v7, s[52:55], s12 offen offset:256
    buffer_load_dwordx2 v[118:119], v7, s[52:55], s12 offen offset:384
    buffer_load_dwordx2 v[144:145], v7, s[52:55], s12 offen offset:2560
    buffer_load_dwordx2 v[146:147], v7, s[52:55], s12 offen offset:2688
    buffer_load_dwordx2 v[148:149], v7, s[52:55], s12 offen offset:2816
    buffer_load_dwordx2 v[150:151], v7, s[52:55], s12 offen offset:2944
    s_add_u32 s12, s12, 5120
    buffer_load_dwordx2 v[152:153], v7, s[52:55], s12 offen offset:0
    buffer_load_dwordx2 v[154:155], v7, s[52:55], s12 offen offset:128
    buffer_load_dwordx2 v[156:157], v7, s[52:55], s12 offen offset:256
    buffer_load_dwordx2 v[158:159], v7, s[52:55], s12 offen offset:384
    buffer_load_dwordx2 v[160:161], v7, s[52:55], s12 offen offset:2560
    buffer_load_dwordx2 v[162:163], v7, s[52:55], s12 offen offset:2688
    buffer_load_dwordx2 v[164:165], v7, s[52:55], s12 offen offset:2816
    buffer_load_dwordx2 v[166:167], v7, s[52:55], s12 offen offset:2944
    s_add_u32 s12, s12, 5120
    buffer_load_dwordx2 v[168:169], v7, s[52:55], s12 offen offset:0
    buffer_load_dwordx2 v[170:171], v7, s[52:55], s12 offen offset:128
    buffer_load_dwordx2 v[172:173], v7, s[52:55], s12 offen offset:256
    buffer_load_dwordx2 v[174:175], v7, s[52:55], s12 offen offset:384
    buffer_load_dwordx2 v[176:177], v7, s[52:55], s12 offen offset:2560
    buffer_load_dwordx2 v[178:179], v7, s[52:55], s12 offen offset:2688
    buffer_load_dwordx2 v[180:181], v7, s[52:55], s12 offen offset:2816
    buffer_load_dwordx2 v[182:183], v7, s[52:55], s12 offen offset:2944
    s_add_u32 s12, s12, 5120
    s_mov_b64 exec, s[42:43]
l3_kernel_noyl:
    s_lshl_b32 s96, s66, 12
    s_mul_i32 s97, s66, 5120
    s_add_u32 s96, s96, s6
    s_add_u32 s97, s97, s8
    s_lshl_b32 s98, s67, 12
    s_mul_i32 s99, s67, 5120
    s_add_u32 s98, s98, s6
    s_add_u32 s99, s99, s8
    s_lshl_b32 s100, s68, 12
    s_mul_i32 s101, s68, 5120
    s_add_u32 s100, s100, s6
    s_add_u32 s101, s101, s8
    v_mov_b32 v12, 0xffff0000
    s_mov_b32 s60, 0xbfb8aa3b
    s_mov_b32 s61, 0xbfb8aa3b
    s_mov_b32 s62, 1.0
    s_mov_b32 s63, 1.0
    s_waitcnt vmcnt(18)
    v_lshlrev_b32 v120, 16, v228
    v_and_b32 v121, v12, v228
    v_pk_add_f32 v[2:3], v[120:121], v[240:241] op_sel_hi:[1,0] neg_lo:[0,1] neg_hi:[0,1]
    v_cvt_pk_bf16_f32 v3, v2, v3
    v_lshlrev_b32 v2, 16, v3
    v_and_b32 v3, v12, v3
    v_pk_mul_f32 v[2:3], v[2:3], v[240:241] op_sel:[0,1]
    v_cvt_pk_bf16_f32 v228, v2, v3
    v_lshlrev_b32 v122, 16, v229
    v_and_b32 v123, v12, v229
    v_pk_add_f32 v[6:7], v[122:123], v[240:241] op_sel_hi:[1,0] neg_lo:[0,1] neg_hi:[0,1]
    v_cvt_pk_bf16_f32 v7, v6, v7
    v_lshlrev_b32 v6, 16, v7
    v_and_b32 v7, v12, v7
    v_pk_mul_f32 v[6:7], v[6:7], v[240:241] op_sel:[0,1]
    v_cvt_pk_bf16_f32 v229, v6, v7
    v_lshlrev_b32 v124, 16, v230
    v_and_b32 v125, v12, v230
    v_pk_add_f32 v[2:3], v[124:125], v[240:241] op_sel_hi:[1,0] neg_lo:[0,1] neg_hi:[0,1]
    v_cvt_pk_bf16_f32 v3, v2, v3
    v_lshlrev_b32 v2, 16, v3
    v_and_b32 v3, v12, v3
    v_pk_mul_f32 v[2:3], v[2:3], v[240:241] op_sel:[0,1]
    v_cvt_pk_bf16_f32 v230, v2, v3
    buffer_load_dwordx4 v[48:51], v197, s[52:55], s96 offen offset:0
    v_lshlrev_b32 v126, 16, v231
    v_and_b32 v127, v12, v231
    v_pk_add_f32 v[6:7], v[126:127], v[240:241] op_sel_hi:[1,0] neg_lo:[0,1] neg_hi:[0,1]
    v_cvt_pk_bf16_f32 v7, v6, v7
    v_lshlrev_b32 v6, 16, v7
    v_and_b32 v7, v12, v7
    v_pk_mul_f32 v[6:7], v[6:7], v[240:241] op_sel:[0,1]
    v_cvt_pk_bf16_f32 v231, v6, v7
    v_lshlrev_b32 v128, 16, v232
    v_and_b32 v129, v12, v232
    v_pk_add_f32 v[2:3], v[128:129], v[242:243] op_sel_hi:[1,0] neg_lo:[0,1] neg_hi:[0,1]
    v_cvt_pk_bf16_f32 v3, v2, v3
    v_lshlrev_b32 v2, 16, v3
    v_and_b32 v3, v12, v3
    v_pk_mul_f32 v[2:3], v[2:3], v[242:243] op_sel:[0,1]
    v_cvt_pk_bf16_f32 v232, v2, v3
    v_lshlrev_b32 v130, 16, v233
    v_and_b32 v131, v12, v233
    v_pk_add_f32 v[6:7], v[130:131], v[242:243] op_sel_hi:[1,0] neg_lo:[0,1] neg_hi:[0,1]
    v_cvt_pk_bf16_f32 v7, v6, v7
    v_lshlrev_b32 v6, 16, v7
    v_and_b32 v7, v12, v7
    v_pk_mul_f32 v[6:7], v[6:7], v[242:243] op_sel:[0,1]
    v_cvt_pk_bf16_f32 v233, v6, v7
    buffer_load_dwordx4 v[52:55], v197, s[52:55], s96 offen offset:1024
    v_lshlrev_b32 v132, 16, v234
    v_and_b32 v133, v12, v234
    v_pk_add_f32 v[2:3], v[132:133], v[242:243] op_sel_hi:[1,0] neg_lo:[0,1] neg_hi:[0,1]
    v_cvt_pk_bf16_f32 v3, v2, v3
    v_lshlrev_b32 v2, 16, v3
    v_and_b32 v3, v12, v3
    v_pk_mul_f32 v[2:3], v[2:3], v[242:243] op_sel:[0,1]
    v_cvt_pk_bf16_f32 v234, v2, v3
    v_lshlrev_b32 v134, 16, v235
    v_and_b32 v135, v12, v235
    v_pk_add_f32 v[6:7], v[134:135], v[242:243] op_sel_hi:[1,0] neg_lo:[0,1] neg_hi:[0,1]
    v_cvt_pk_bf16_f32 v7, v6, v7
    v_lshlrev_b32 v6, 16, v7
    v_and_b32 v7, v12, v7
    v_pk_mul_f32 v[6:7], v[6:7], v[242:243] op_sel:[0,1]
    v_cvt_pk_bf16_f32 v235, v6, v7
    v_lshlrev_b32 v136, 16, v236
    v_and_b32 v137, v12, v236
    v_pk_add_f32 v[2:3], v[136:137], v[244:245] op_sel_hi:[1,0] neg_lo:[0,1] neg_hi:[0,1]
    v_cvt_pk_bf16_f32 v3, v2, v3
    v_lshlrev_b32 v2, 16, v3
    v_and_b32 v3, v12, v3
    v_pk_mul_f32 v[2:3], v[2:3], v[244:245] op_sel:[0,1]
    v_cvt_pk_bf16_f32 v236, v2, v3
    buffer_load_dwordx4 v[56:59], v197, s[52:55], s96 offen offset:2048
    v_lshlrev_b32 v138, 16, v237
    v_and_b32 v139, v12, v237
    v_pk_add_f32 v[6:7], v[138:139], v[244:245] op_sel_hi:[1,0] neg_lo:[0,1] neg_hi:[0,1]
    v_cvt_pk_bf16_f32 v7, v6, v7
    v_lshlrev_b32 v6, 16, v7
    v_and_b32 v7, v12, v7
    v_pk_mul_f32 v[6:7], v[6:7], v[244:245] op_sel:[0,1]
    v_cvt_pk_bf16_f32 v237, v6, v7
    v_lshlrev_b32 v140, 16, v238
    v_and_b32 v141, v12, v238
    v_pk_add_f32 v[2:3], v[140:141], v[244:245] op_sel_hi:[1,0] neg_lo:[0,1] neg_hi:[0,1]
    v_cvt_pk_bf16_f32 v3, v2, v3
    v_lshlrev_b32 v2, 16, v3
    v_and_b32 v3, v12, v3
    v_pk_mul_f32 v[2:3], v[2:3], v[244:245] op_sel:[0,1]
    v_cvt_pk_bf16_f32 v238, v2, v3
    v_lshlrev_b32 v142, 16, v239
    v_and_b32 v143, v12, v239
    v_pk_add_f32 v[6:7], v[142:143], v[244:245] op_sel_hi:[1,0] neg_lo:[0,1] neg_hi:[0,1]
    v_cvt_pk_bf16_f32 v7, v6, v7
    v_lshlrev_b32 v6, 16, v7
    v_and_b32 v7, v12, v7
    v_pk_mul_f32 v[6:7], v[6:7], v[244:245] op_sel:[0,1]
    v_cvt_pk_bf16_f32 v239, v6, v7
    buffer_load_dwordx4 v[60:63], v197, s[52:55], s96 offen offset:3072
    s_lshr_b32 s12, s14, 4
    s_lshl_b32 s13, s4, 2
    s_add_u32 s13, s13, s3
    s_cmp_lg_u32 s12, s13
    s_cbranch_scc1 l3_kernel_noy
    s_waitcnt vmcnt(4)
    v_pk_add_f32 v[96:97], v[96:97], v[104:105]
    v_pk_add_f32 v[98:99], v[98:99], v[106:107]
    v_pk_add_f32 v[100:101], v[100:101], v[108:109]
    v_pk_add_f32 v[102:103], v[102:103], v[110:111]
    v_pk_add_f32 v[96:97], v[96:97], v[112:113]
    v_pk_add_f32 v[98:99], v[98:99], v[114:115]
    v_pk_add_f32 v[100:101], v[100:101], v[116:117]
    v_pk_add_f32 v[102:103], v[102:103], v[118:119]
    v_pk_add_f32 v[96:97], v[96:97], v[144:145]
    v_pk_add_f32 v[98:99], v[98:99], v[146:147]
    v_pk_add_f32 v[100:101], v[100:101], v[148:149]
    v_pk_add_f32 v[102:103], v[102:103], v[150:151]
    v_pk_add_f32 v[96:97], v[96:97], v[152:153]
    v_pk_add_f32 v[98:99], v[98:99], v[154:155]
    v_pk_add_f32 v[100:101], v[100:101], v[156:157]
    v_pk_add_f32 v[102:103], v[102:103], v[158:159]
    v_pk_add_f32 v[96:97], v[96:97], v[160:161]
    v_pk_add_f32 v[98:99], v[98:99], v[162:163]
    v_pk_add_f32 v[100:101], v[100:101], v[164:165]
    v_pk_add_f32 v[102:103], v[102:103], v[166:167]
    v_pk_add_f32 v[96:97], v[96:97], v[168:169]
    v_pk_add_f32 v[98:99], v[98:99], v[170:171]
    v_pk_add_f32 v[100:101], v[100:101], v[172:173]
    v_pk_add_f32 v[102:103], v[102:103], v[174:175]
    v_pk_add_f32 v[96:97], v[96:97], v[176:177]
    v_pk_add_f32 v[98:99], v[98:99], v[178:179]
    v_pk_add_f32 v[100:101], v[100:101], v[180:181]
    v_pk_add_f32 v[102:103], v[102:103], v[182:183]
    v_cvt_pk_bf16_f32 v96, v96, v97
    v_and_b32 v97, v12, v96
    v_lshlrev_b32 v96, 16, v96
    v_mul_f32 v96, s15, v96
    v_mul_f32 v97, s15, v97
    v_cvt_pk_bf16_f32 v96, v96, v97
    v_and_b32 v97, v12, v96
    v_lshlrev_b32 v96, 16, v96
    v_cvt_pk_bf16_f32 v98, v98, v99
    v_and_b32 v99, v12, v98
    v_lshlrev_b32 v98, 16, v98
    v_mul_f32 v98, s15, v98
    v_mul_f32 v99, s15, v99
    v_cvt_pk_bf16_f32 v98, v98, v99
    v_and_b32 v99, v12, v98
    v_lshlrev_b32 v98, 16, v98
    v_cvt_pk_bf16_f32 v100, v100, v101
    v_and_b32 v101, v12, v100
    v_lshlrev_b32 v100, 16, v100
    v_mul_f32 v100, s15, v100
    v_mul_f32 v101, s15, v101
    v_cvt_pk_bf16_f32 v100, v100, v101
    v_and_b32 v101, v12, v100
    v_lshlrev_b32 v100, 16, v100
    v_cvt_pk_bf16_f32 v102, v102, v103
    v_and_b32 v103, v12, v102
    v_lshlrev_b32 v102, 16, v102
    v_mul_f32 v102, s15, v102
    v_mul_f32 v103, s15, v103
    v_cvt_pk_bf16_f32 v102, v102, v103
    v_and_b32 v103, v12, v102
    v_lshlrev_b32 v102, 16, v102
    s_and_b32 s12, s14, 15
    s_lshl_b32 s12, s12, 3
    v_cmp_eq_u32 vcc, s12, v249
    s_and_saveexec_b64 s[42:43], vcc
    v_lshlrev_b32 v2, 16, v228
    v_and_b32 v3, v12, v228
    v_pk_add_f32 v[2:3], v[2:3], v[96:97]
    v_cvt_pk_bf16_f32 v228, v2, v3
    v_lshlrev_b32 v2, 16, v229
    v_and_b32 v3, v12, v229
    v_pk_add_f32 v[2:3], v[2:3], v[98:99]
    v_cvt_pk_bf16_f32 v229, v2, v3
    v_lshlrev_b32 v2, 16, v230
    v_and_b32 v3, v12, v230
    v_pk_add_f32 v[2:3], v[2:3], v[100:101]
    v_cvt_pk_bf16_f32 v230, v2, v3
    v_lshlrev_b32 v2, 16, v231
    v_and_b32 v3, v12, v231
    v_pk_add_f32 v[2:3], v[2:3], v[102:103]
    v_cvt_pk_bf16_f32 v231, v2, v3
    s_mov_b64 exec, s[42:43]
    v_cmp_eq_u32 vcc, s12, v250
    s_and_saveexec_b64 s[42:43], vcc
    v_lshlrev_b32 v2, 16, v232
    v_and_b32 v3, v12, v232
    v_pk_add_f32 v[2:3], v[2:3], v[96:97]
    v_cvt_pk_bf16_f32 v232, v2, v3
    v_lshlrev_b32 v2, 16, v233
    v_and_b32 v3, v12, v233
    v_pk_add_f32 v[2:3], v[2:3], v[98:99]
    v_cvt_pk_bf16_f32 v233, v2, v3
    v_lshlrev_b32 v2, 16, v234
    v_and_b32 v3, v12, v234
    v_pk_add_f32 v[2:3], v[2:3], v[100:101]
    v_cvt_pk_bf16_f32 v234, v2, v3
    v_lshlrev_b32 v2, 16, v235
    v_and_b32 v3, v12, v235
    v_pk_add_f32 v[2:3], v[2:3], v[102:103]
    v_cvt_pk_bf16_f32 v235, v2, v3
    s_mov_b64 exec, s[42:43]
    v_cmp_eq_u32 vcc, s12, v251
    s_and_saveexec_b64 s[42:43], vcc
    v_lshlrev_b32 v2, 16, v236
    v_and_b32 v3, v12, v236
    v_pk_add_f32 v[2:3], v[2:3], v[96:97]
    v_cvt_pk_bf16_f32 v236, v2, v3
    v_lshlrev_b32 v2, 16, v237
    v_and_b32 v3, v12, v237
    v_pk_add_f32 v[2:3], v[2:3], v[98:99]
    v_cvt_pk_bf16_f32 v237, v2, v3
    v_lshlrev_b32 v2, 16, v238
    v_and_b32 v3, v12, v238
    v_pk_add_f32 v[2:3], v[2:3], v[100:101]
    v_cvt_pk_bf16_f32 v238, v2, v3
    v_lshlrev_b32 v2, 16, v239
    v_and_b32 v3, v12, v239
    v_pk_add_f32 v[2:3], v[2:3], v[102:103]
    v_cvt_pk_bf16_f32 v239, v2, v3
    s_mov_b64 exec, s[42:43]
l3_kernel_noy:
    v_lshlrev_b32 v204, 16, v228
    v_and_b32 v205, v12, v228
    v_pk_mul_f32 v[2:3], v[204:205], s[60:61]
    v_exp_f32 v2, v2
    v_exp_f32 v3, v3
    s_nop 0
    v_pk_add_f32 v[2:3], v[2:3], s[62:63]
    v_rcp_f32 v2, v2
    v_rcp_f32 v3, v3
    s_nop 0
    v_pk_mul_f32 v[2:3], v[2:3], v[204:205]
    v_cvt_pk_bf16_f32 v205, v2, v3
    v_lshlrev_b32 v204, 16, v205
    v_and_b32 v205, v12, v205
    s_add_u32 m0, s11, 40960
    s_nop 0
    buffer_load_dwordx4 v192, s[48:51], s97 offen lds
    s_add_u32 m0, s11, 41984
    s_nop 0
    buffer_load_dwordx4 v193, s[48:51], s97 offen lds
    v_lshlrev_b32 v206, 16, v229
    v_and_b32 v207, v12, v229
    v_pk_mul_f32 v[6:7], v[206:207], s[60:61]
    v_exp_f32 v6, v6
    v_exp_f32 v7, v7
    s_nop 0
    v_pk_add_f32 v[6:7], v[6:7], s[62:63]
    v_rcp_f32 v6, v6
    v_rcp_f32 v7, v7
    s_nop 0
    v_pk_mul_f32 v[6:7], v[6:7], v[206:207]
    v_cvt_pk_bf16_f32 v207, v6, v7
    v_lshlrev_b32 v206, 16, v207
    v_and_b32 v207, v12, v207
    s_add_u32 m0, s11, 43008
    s_nop 0
    buffer_load_dwordx4 v194, s[48:51], s97 offen lds
    s_add_u32 m0, s11, 44032
    s_nop 0
    buffer_load_dwordx4 v195, s[48:51], s97 offen lds
    v_lshlrev_b32 v208, 16, v230
    v_and_b32 v209, v12, v230
    v_pk_mul_f32 v[2:3], v[208:209], s[60:61]
    v_exp_f32 v2, v2
    v_exp_f32 v3, v3
    s_nop 0
    v_pk_add_f32 v[2:3], v[2:3], s[62:63]
    v_rcp_f32 v2, v2
    v_rcp_f32 v3, v3
    s_nop 0
    v_pk_mul_f32 v[2:3], v[2:3], v[208:209]
    v_cvt_pk_bf16_f32 v209, v2, v3
    v_lshlrev_b32 v208, 16, v209
    v_and_b32 v209, v12, v209
    s_add_u32 m0, s11, 45056
    s_nop 0
    buffer_load_dwordx4 v196, s[48:51], s97 offen lds
    v_lshlrev_b32 v210, 16, v231
    v_and_b32 v211, v12, v231
    v_pk_mul_f32 v[6:7], v[210:211], s[60:61]
    v_exp_f32 v6, v6
    v_exp_f32 v7, v7
    s_nop 0
    v_pk_add_f32 v[6:7], v[6:7], s[62:63]
    v_rcp_f32 v6, v6
    v_rcp_f32 v7, v7
    s_nop 0
    v_pk_mul_f32 v[6:7], v[6:7], v[210:211]
    v_cvt_pk_bf16_f32 v211, v6, v7
    v_lshlrev_b32 v210, 16, v211
    v_and_b32 v211, v12, v211
    buffer_load_dwordx4 v[64:67], v197, s[52:55], s98 offen offset:0
    v_lshlrev_b32 v212, 16, v232
    v_and_b32 v213, v12, v232
    v_pk_mul_f32 v[2:3], v[212:213], s[60:61]
    v_exp_f32 v2, v2
    v_exp_f32 v3, v3
    s_nop 0
    v_pk_add_f32 v[2:3], v[2:3], s[62:63]
    v_rcp_f32 v2, v2
    v_rcp_f32 v3, v3
    s_nop 0
    v_pk_mul_f32 v[2:3], v[2:3], v[212:213]
    v_cvt_pk_bf16_f32 v213, v2, v3
    v_lshlrev_b32 v212, 16, v213
    v_and_b32 v213, v12, v213
    buffer_load_dwordx4 v[68:71], v197, s[52:55], s98 offen offset:1024
    v_lshlrev_b32 v214, 16, v233
    v_and_b32 v215, v12, v233
    v_pk_mul_f32 v[6:7], v[214:215], s[60:61]
    v_exp_f32 v6, v6
    v_exp_f32 v7, v7
    s_nop 0
    v_pk_add_f32 v[6:7], v[6:7], s[62:63]
    v_rcp_f32 v6, v6
    v_rcp_f32 v7, v7
    s_nop 0
    v_pk_mul_f32 v[6:7], v[6:7], v[214:215]
    v_cvt_pk_bf16_f32 v215, v6, v7
    v_lshlrev_b32 v214, 16, v215
    v_and_b32 v215, v12, v215
    buffer_load_dwordx4 v[72:75], v197, s[52:55], s98 offen offset:2048
    v_lshlrev_b32 v216, 16, v234
    v_and_b32 v217, v12, v234
    v_pk_mul_f32 v[2:3], v[216:217], s[60:61]
    v_exp_f32 v2, v2
    v_exp_f32 v3, v3
    s_nop 0
    v_pk_add_f32 v[2:3], v[2:3], s[62:63]
    v_rcp_f32 v2, v2
    v_rcp_f32 v3, v3
    s_nop 0
    v_pk_mul_f32 v[2:3], v[2:3], v[216:217]
    v_cvt_pk_bf16_f32 v217, v2, v3
    v_lshlrev_b32 v216, 16, v217
    v_and_b32 v217, v12, v217
    buffer_load_dwordx4 v[76:79], v197, s[52:55], s98 offen offset:3072
    v_lshlrev_b32 v218, 16, v235
    v_and_b32 v219, v12, v235
    v_pk_mul_f32 v[6:7], v[218:219], s[60:61]
    v_exp_f32 v6, v6
    v_exp_f32 v7, v7
    s_nop 0
    v_pk_add_f32 v[6:7], v[6:7], s[62:63]
    v_rcp_f32 v6, v6
    v_rcp_f32 v7, v7
    s_nop 0
    v_pk_mul_f32 v[6:7], v[6:7], v[218:219]
    v_cvt_pk_bf16_f32 v219, v6, v7
    v_lshlrev_b32 v218, 16, v219
    v_and_b32 v219, v12, v219
    s_add_u32 m0, s11, 61440
    s_nop 0
    buffer_load_dwordx4 v192, s[48:51], s99 offen lds
    v_lshlrev_b32 v220, 16, v236
    v_and_b32 v221, v12, v236
    v_pk_mul_f32 v[2:3], v[220:221], s[60:61]
    v_exp_f32 v2, v2
    v_exp_f32 v3, v3
    s_nop 0
    v_pk_add_f32 v[2:3], v[2:3], s[62:63]
    v_rcp_f32 v2, v2
    v_rcp_f32 v3, v3
    s_nop 0
    v_pk_mul_f32 v[2:3], v[2:3], v[220:221]
    v_cvt_pk_bf16_f32 v221, v2, v3
    v_lshlrev_b32 v220, 16, v221
    v_and_b32 v221, v12, v221
    s_add_u32 m0, s11, 62464
    s_nop 0
    buffer_load_dwordx4 v193, s[48:51], s99 offen lds
    v_lshlrev_b32 v222, 16, v237
    v_and_b32 v223, v12, v237
    v_pk_mul_f32 v[6:7], v[222:223], s[60:61]
    v_exp_f32 v6, v6
    v_exp_f32 v7, v7
    s_nop 0
    v_pk_add_f32 v[6:7], v[6:7], s[62:63]
    v_rcp_f32 v6, v6
    v_rcp_f32 v7, v7
    s_nop 0
    v_pk_mul_f32 v[6:7], v[6:7], v[222:223]
    v_cvt_pk_bf16_f32 v223, v6, v7
    v_lshlrev_b32 v222, 16, v223
    v_and_b32 v223, v12, v223
    s_add_u32 m0, s11, 63488
    s_nop 0
    buffer_load_dwordx4 v194, s[48:51], s99 offen lds
    v_lshlrev_b32 v224, 16, v238
    v_and_b32 v225, v12, v238
    v_pk_mul_f32 v[2:3], v[224:225], s[60:61]
    v_exp_f32 v2, v2
    v_exp_f32 v3, v3
    s_nop 0
    v_pk_add_f32 v[2:3], v[2:3], s[62:63]
    v_rcp_f32 v2, v2
    v_rcp_f32 v3, v3
    s_nop 0
    v_pk_mul_f32 v[2:3], v[2:3], v[224:225]
    v_cvt_pk_bf16_f32 v225, v2, v3
    v_lshlrev_b32 v224, 16, v225
    v_and_b32 v225, v12, v225
    s_add_u32 m0, s11, 64512
    s_nop 0
    buffer_load_dwordx4 v195, s[48:51], s99 offen lds
    v_lshlrev_b32 v226, 16, v239
    v_and_b32 v227, v12, v239
    v_pk_mul_f32 v[6:7], v[226:227], s[60:61]
    v_exp_f32 v6, v6
    v_exp_f32 v7, v7
    s_nop 0
    v_pk_add_f32 v[6:7], v[6:7], s[62:63]
    v_rcp_f32 v6, v6
    v_rcp_f32 v7, v7
    s_nop 0
    v_pk_mul_f32 v[6:7], v[6:7], v[226:227]
    v_cvt_pk_bf16_f32 v227, v6, v7
    v_lshlrev_b32 v226, 16, v227
    v_and_b32 v227, v12, v227
    s_add_u32 m0, s11, 65536
    s_nop 0
    buffer_load_dwordx4 v196, s[48:51], s99 offen lds
    s_mul_i32 s12, s3, 2560
    s_add_u32 s12, s12, 110592
    v_and_b32 v2, 15, v0
    v_lshrrev_b32 v3, 4, v0
    v_mul_u32_u24 v2, 160, v2
    v_mad_u32_u24 v2, v3, 40, v2
    v_add_u32 v13, s12, v2
    v_lshl_add_u32 v14, v0, 4, s12
    s_waitcnt vmcnt(27)
    s_barrier
    ds_read_b64_tr_b16 v[144:145], v198 offset:0
    ds_read_b64_tr_b16 v[146:147], v198 offset:2560
    ds_read_b64_tr_b16 v[148:149], v198 offset:8
    ds_read_b64_tr_b16 v[150:151], v198 offset:2568
    ds_read_b64_tr_b16 v[152:153], v198 offset:16
    ds_read_b64_tr_b16 v[154:155], v198 offset:2576
    ds_read_b64_tr_b16 v[156:157], v198 offset:24
    ds_read_b64_tr_b16 v[158:159], v198 offset:2584
    ds_read_b64_tr_b16 v[160:161], v198 offset:32
    ds_read_b64_tr_b16 v[162:163], v198 offset:2592
    ds_read_b64_tr_b16 v[168:169], v198 offset:5120
    ds_read_b64_tr_b16 v[170:171], v198 offset:7680
    s_waitcnt lgkmcnt(10)
    v_mfma_f32_16x16x32_bf16 v[96:99], v[144:147], v[16:19], 0
    buffer_load_dwordx4 v[80:83], v197, s[52:55], s100 offen offset:0
    ds_read_b64_tr_b16 v[172:173], v198 offset:5128
    ds_read_b64_tr_b16 v[174:175], v198 offset:7688
    s_waitcnt lgkmcnt(10)
    v_mfma_f32_16x16x32_bf16 v[100:103], v[148:151], v[16:19], 0
    ds_read_b64_tr_b16 v[176:177], v198 offset:5136
    ds_read_b64_tr_b16 v[178:179], v198 offset:7696
    s_waitcnt lgkmcnt(10)
    v_mfma_f32_16x16x32_bf16 v[104:107], v[152:155], v[16:19], 0
    buffer_load_dwordx4 v[84:87], v197, s[52:55], s100 offen offset:1024
    ds_read_b64_tr_b16 v[180:181], v198 offset:5144
    ds_read_b64_tr_b16 v[182:183], v198 offset:7704
    s_waitcnt lgkmcnt(10)
    v_mfma_f32_16x16x32_bf16 v[108:111], v[156:159], v[16:19], 0
    ds_read_b64_tr_b16 v[184:185], v198 offset:5152
    ds_read_b64_tr_b16 v[186:187], v198 offset:7712
    s_waitcnt lgkmcnt(10)
    v_mfma_f32_16x16x32_bf16 v[112:115], v[160:163], v[16:19], 0
    buffer_load_dwordx4 v[88:91], v197, s[52:55], s100 offen offset:2048
    ds_read_b64_tr_b16 v[144:145], v198 offset:10240
    ds_read_b64_tr_b16 v[146:147], v198 offset:12800
    s_waitcnt lgkmcnt(10)
    v_mfma_f32_16x16x32_bf16 v[96:99], v[168:171], v[20:23], v[96:99]
    buffer_load_dwordx4 v[92:95], v197, s[52:55], s100 offen offset:3072
    ds_read_b64_tr_b16 v[148:149], v198 offset:10248
    ds_read_b64_tr_b16 v[150:151], v198 offset:12808
    s_waitcnt lgkmcnt(10)
    v_mfma_f32_16x16x32_bf16 v[100:103], v[172:175], v[20:23], v[100:103]
    ds_read_b64_tr_b16 v[152:153], v198 offset:10256
    ds_read_b64_tr_b16 v[154:155], v198 offset:12816
    s_waitcnt lgkmcnt(10)
    v_mfma_f32_16x16x32_bf16 v[104:107], v[176:179], v[20:23], v[104:107]
    s_add_u32 m0, s11, 81920
    s_nop 0
    buffer_load_dwordx4 v192, s[48:51], s101 offen lds
    ds_read_b64_tr_b16 v[156:157], v198 offset:10264
    ds_read_b64_tr_b16 v[158:159], v198 offset:12824
    s_waitcnt lgkmcnt(10)
    v_mfma_f32_16x16x32_bf16 v[108:111], v[180:183], v[20:23], v[108:111]
    ds_read_b64_tr_b16 v[160:161], v198 offset:10272
    ds_read_b64_tr_b16 v[162:163], v198 offset:12832
    s_waitcnt lgkmcnt(10)
    v_mfma_f32_16x16x32_bf16 v[112:115], v[184:187], v[20:23], v[112:115]
    s_add_u32 m0, s11, 82944
    s_nop 0
    buffer_load_dwordx4 v193, s[48:51], s101 offen lds
    ds_read_b64_tr_b16 v[168:169], v198 offset:15360
    ds_read_b64_tr_b16 v[170:171], v198 offset:17920
    s_waitcnt lgkmcnt(10)
    v_mfma_f32_16x16x32_bf16 v[96:99], v[144:147], v[24:27], v[96:99]
    s_add_u32 m0, s11, 83968
    s_nop 0
    buffer_load_dwordx4 v194, s[48:51], s101 offen lds
    ds_read_b64_tr_b16 v[172:173], v198 offset:15368
    ds_read_b64_tr_b16 v[174:175], v198 offset:17928
    s_waitcnt lgkmcnt(10)
    v_mfma_f32_16x16x32_bf16 v[100:103], v[148:151], v[24:27], v[100:103]
    ds_read_b64_tr_b16 v[176:177], v198 offset:15376
    ds_read_b64_tr_b16 v[178:179], v198 offset:17936
    s_waitcnt lgkmcnt(10)
    v_mfma_f32_16x16x32_bf16 v[104:107], v[152:155], v[24:27], v[104:107]
    s_add_u32 m0, s11, 84992
    s_nop 0
    buffer_load_dwordx4 v195, s[48:51], s101 offen lds
    ds_read_b64_tr_b16 v[180:181], v198 offset:15384
    ds_read_b64_tr_b16 v[182:183], v198 offset:17944
    s_waitcnt lgkmcnt(10)
    v_mfma_f32_16x16x32_bf16 v[108:111], v[156:159], v[24:27], v[108:111]
    ds_read_b64_tr_b16 v[184:185], v198 offset:15392
    ds_read_b64_tr_b16 v[186:187], v198 offset:17952
    s_waitcnt lgkmcnt(10)
    v_mfma_f32_16x16x32_bf16 v[112:115], v[160:163], v[24:27], v[112:115]
    s_add_u32 m0, s11, 86016
    s_nop 0
    buffer_load_dwordx4 v196, s[48:51], s101 offen lds
    s_waitcnt vmcnt(27)
    s_barrier
    ds_read_b64_tr_b16 v[144:145], v198 offset:20480
    ds_read_b64_tr_b16 v[146:147], v198 offset:23040
    s_waitcnt lgkmcnt(10)
    v_mfma_f32_16x16x32_bf16 v[96:99], v[168:171], v[28:31], v[96:99]
    ds_read_b64_tr_b16 v[148:149], v198 offset:20488
    ds_read_b64_tr_b16 v[150:151], v198 offset:23048
    s_waitcnt lgkmcnt(10)
    v_mfma_f32_16x16x32_bf16 v[100:103], v[172:175], v[28:31], v[100:103]
    ds_read_b64_tr_b16 v[152:153], v198 offset:20496
    ds_read_b64_tr_b16 v[154:155], v198 offset:23056
    s_waitcnt lgkmcnt(10)
    v_mfma_f32_16x16x32_bf16 v[104:107], v[176:179], v[28:31], v[104:107]
    ds_read_b64_tr_b16 v[156:157], v198 offset:20504
    ds_read_b64_tr_b16 v[158:159], v198 offset:23064
    s_waitcnt lgkmcnt(10)
    v_mfma_f32_16x16x32_bf16 v[108:111], v[180:183], v[28:31], v[108:111]
    ds_read_b64_tr_b16 v[160:161], v198 offset:20512
    ds_read_b64_tr_b16 v[162:163], v198 offset:23072
    s_waitcnt lgkmcnt(10)
    v_mfma_f32_16x16x32_bf16 v[112:115], v[184:187], v[28:31], v[112:115]
    ds_read_b64_tr_b16 v[168:169], v198 offset:25600
    ds_read_b64_tr_b16 v[170:171], v198 offset:28160
    s_waitcnt lgkmcnt(10)
    v_mfma_f32_16x16x32_bf16 v[96:99], v[144:147], v[32:35], v[96:99]
    ds_read_b64_tr_b16 v[172:173], v198 offset:25608
    ds_read_b64_tr_b16 v[174:175], v198 offset:28168
    s_waitcnt lgkmcnt(10)
    v_mfma_f32_16x16x32_bf16 v[100:103], v[148:151], v[32:35], v[100:103]
    ds_read_b64_tr_b16 v[176:177], v198 offset:25616
    ds_read_b64_tr_b16 v[178:179], v198 offset:28176
    s_waitcnt lgkmcnt(10)
    v_mfma_f32_16x16x32_bf16 v[104:107], v[152:155], v[32:35], v[104:107]
    ds_read_b64_tr_b16 v[180:181], v198 offset:25624
    ds_read_b64_tr_b16 v[182:183], v198 offset:28184
    s_waitcnt lgkmcnt(10)
    v_mfma_f32_16x16x32_bf16 v[108:111], v[156:159], v[32:35], v[108:111]
    ds_read_b64_tr_b16 v[184:185], v198 offset:25632
    ds_read_b64_tr_b16 v[186:187], v198 offset:28192
    s_waitcnt lgkmcnt(10)
    v_mfma_f32_16x16x32_bf16 v[112:115], v[160:163], v[32:35], v[112:115]
    ds_read_b64_tr_b16 v[144:145], v198 offset:30720
    ds_read_b64_tr_b16 v[146:147], v198 offset:33280
    s_waitcnt lgkmcnt(10)
    v_mfma_f32_16x16x32_bf16 v[96:99], v[168:171], v[36:39], v[96:99]
    ds_read_b64_tr_b16 v[148:149], v198 offset:30728
    ds_read_b64_tr_b16 v[150:151], v198 offset:33288
    s_waitcnt lgkmcnt(10)
    v_mfma_f32_16x16x32_bf16 v[100:103], v[172:175], v[36:39], v[100:103]
    ds_read_b64_tr_b16 v[152:153], v198 offset:30736
    ds_read_b64_tr_b16 v[154:155], v198 offset:33296
    s_waitcnt lgkmcnt(10)
    v_mfma_f32_16x16x32_bf16 v[104:107], v[176:179], v[36:39], v[104:107]
    ds_read_b64_tr_b16 v[156:157], v198 offset:30744
    ds_read_b64_tr_b16 v[158:159], v198 offset:33304
    s_waitcnt lgkmcnt(10)
    v_mfma_f32_16x16x32_bf16 v[108:111], v[180:183], v[36:39], v[108:111]
    ds_read_b64_tr_b16 v[160:161], v198 offset:30752
    ds_read_b64_tr_b16 v[162:163], v198 offset:33312
    s_waitcnt lgkmcnt(10)
    v_mfma_f32_16x16x32_bf16 v[112:115], v[184:187], v[36:39], v[112:115]
    ds_read_b64_tr_b16 v[168:169], v198 offset:35840
    ds_read_b64_tr_b16 v[170:171], v198 offset:38400
    s_waitcnt lgkmcnt(10)
    v_mfma_f32_16x16x32_bf16 v[96:99], v[144:147], v[40:43], v[96:99]
    ds_read_b64_tr_b16 v[172:173], v198 offset:35848
    ds_read_b64_tr_b16 v[174:175], v198 offset:38408
    s_waitcnt lgkmcnt(10)
    v_mfma_f32_16x16x32_bf16 v[100:103], v[148:151], v[40:43], v[100:103]
    ds_read_b64_tr_b16 v[176:177], v198 offset:35856
    ds_read_b64_tr_b16 v[178:179], v198 offset:38416
    s_waitcnt lgkmcnt(10)
    v_mfma_f32_16x16x32_bf16 v[104:107], v[152:155], v[40:43], v[104:107]
    ds_read_b64_tr_b16 v[180:181], v198 offset:35864
    ds_read_b64_tr_b16 v[182:183], v198 offset:38424
    s_waitcnt lgkmcnt(10)
    v_mfma_f32_16x16x32_bf16 v[108:111], v[156:159], v[40:43], v[108:111]
    ds_read_b64_tr_b16 v[184:185], v198 offset:35872
    ds_read_b64_tr_b16 v[186:187], v198 offset:38432
    s_waitcnt lgkmcnt(10)
    v_mfma_f32_16x16x32_bf16 v[112:115], v[160:163], v[40:43], v[112:115]
    s_waitcnt vmcnt(18)
    s_barrier
    ds_read_b64_tr_b16 v[144:145], v198 offset:40960
    ds_read_b64_tr_b16 v[146:147], v198 offset:43520
    s_waitcnt lgkmcnt(10)
    v_mfma_f32_16x16x32_bf16 v[96:99], v[168:171], v[44:47], v[96:99]
    ds_read_b64_tr_b16 v[148:149], v198 offset:40968
    ds_read_b64_tr_b16 v[150:151], v198 offset:43528
    s_waitcnt lgkmcnt(10)
    v_mfma_f32_16x16x32_bf16 v[100:103], v[172:175], v[44:47], v[100:103]
    ds_read_b64_tr_b16 v[152:153], v198 offset:40976
    ds_read_b64_tr_b16 v[154:155], v198 offset:43536
    s_waitcnt lgkmcnt(10)
    v_mfma_f32_16x16x32_bf16 v[104:107], v[176:179], v[44:47], v[104:107]
    ds_read_b64_tr_b16 v[156:157], v198 offset:40984
    ds_read_b64_tr_b16 v[158:159], v198 offset:43544
    s_waitcnt lgkmcnt(10)
    v_mfma_f32_16x16x32_bf16 v[108:111], v[180:183], v[44:47], v[108:111]
    ds_read_b64_tr_b16 v[160:161], v198 offset:40992
    ds_read_b64_tr_b16 v[162:163], v198 offset:43552
    s_waitcnt lgkmcnt(10)
    v_mfma_f32_16x16x32_bf16 v[112:115], v[184:187], v[44:47], v[112:115]
    ds_read_b64_tr_b16 v[168:169], v198 offset:46080
    ds_read_b64_tr_b16 v[170:171], v198 offset:48640
    s_waitcnt lgkmcnt(10)
    v_mfma_f32_16x16x32_bf16 v[96:99], v[144:147], v[48:51], v[96:99]
    ds_read_b64_tr_b16 v[172:173], v198 offset:46088
    ds_read_b64_tr_b16 v[174:175], v198 offset:48648
    s_waitcnt lgkmcnt(10)
    v_mfma_f32_16x16x32_bf16 v[100:103], v[148:151], v[48:51], v[100:103]
    ds_read_b64_tr_b16 v[176:177], v198 offset:46096
    ds_read_b64_tr_b16 v[178:179], v198 offset:48656
    s_waitcnt lgkmcnt(10)
    v_mfma_f32_16x16x32_bf16 v[104:107], v[152:155], v[48:51], v[104:107]
    ds_read_b64_tr_b16 v[180:181], v198 offset:46104
    ds_read_b64_tr_b16 v[182:183], v198 offset:48664
    s_waitcnt lgkmcnt(10)
    v_mfma_f32_16x16x32_bf16 v[108:111], v[156:159], v[48:51], v[108:111]
    ds_read_b64_tr_b16 v[184:185], v198 offset:46112
    ds_read_b64_tr_b16 v[186:187], v198 offset:48672
    s_waitcnt lgkmcnt(10)
    v_mfma_f32_16x16x32_bf16 v[112:115], v[160:163], v[48:51], v[112:115]
    ds_read_b64_tr_b16 v[144:145], v198 offset:51200
    ds_read_b64_tr_b16 v[146:147], v198 offset:53760
    s_waitcnt lgkmcnt(10)
    v_mfma_f32_16x16x32_bf16 v[96:99], v[168:171], v[52:55], v[96:99]
    ds_read_b64_tr_b16 v[148:149], v198 offset:51208
    ds_read_b64_tr_b16 v[150:151], v198 offset:53768
    s_waitcnt lgkmcnt(10)
    v_mfma_f32_16x16x32_bf16 v[100:103], v[172:175], v[52:55], v[100:103]
    ds_read_b64_tr_b16 v[152:153], v198 offset:51216
    ds_read_b64_tr_b16 v[154:155], v198 offset:53776
    s_waitcnt lgkmcnt(10)
    v_mfma_f32_16x16x32_bf16 v[104:107], v[176:179], v[52:55], v[104:107]
    ds_read_b64_tr_b16 v[156:157], v198 offset:51224
    ds_read_b64_tr_b16 v[158:159], v198 offset:53784
    s_waitcnt lgkmcnt(10)
    v_mfma_f32_16x16x32_bf16 v[108:111], v[180:183], v[52:55], v[108:111]
    ds_read_b64_tr_b16 v[160:161], v198 offset:51232
    ds_read_b64_tr_b16 v[162:163], v198 offset:53792
    s_waitcnt lgkmcnt(10)
    v_mfma_f32_16x16x32_bf16 v[112:115], v[184:187], v[52:55], v[112:115]
    ds_read_b64_tr_b16 v[168:169], v198 offset:56320
    ds_read_b64_tr_b16 v[170:171], v198 offset:58880
    s_waitcnt lgkmcnt(10)
    v_mfma_f32_16x16x32_bf16 v[96:99], v[144:147], v[56:59], v[96:99]
    ds_read_b64_tr_b16 v[172:173], v198 offset:56328
    ds_read_b64_tr_b16 v[174:175], v198 offset:58888
    s_waitcnt lgkmcnt(10)
    v_mfma_f32_16x16x32_bf16 v[100:103], v[148:151], v[56:59], v[100:103]
    ds_read_b64_tr_b16 v[176:177], v198 offset:56336
    ds_read_b64_tr_b16 v[178:179], v198 offset:58896
    s_waitcnt lgkmcnt(10)
    v_mfma_f32_16x16x32_bf16 v[104:107], v[152:155], v[56:59], v[104:107]
    ds_read_b64_tr_b16 v[180:181], v198 offset:56344
    ds_read_b64_tr_b16 v[182:183], v198 offset:58904
    s_waitcnt lgkmcnt(10)
    v_mfma_f32_16x16x32_bf16 v[108:111], v[156:159], v[56:59], v[108:111]
    ds_read_b64_tr_b16 v[184:185], v198 offset:56352
    ds_read_b64_tr_b16 v[186:187], v198 offset:58912
    s_waitcnt lgkmcnt(10)
    v_mfma_f32_16x16x32_bf16 v[112:115], v[160:163], v[56:59], v[112:115]
    s_waitcnt vmcnt(9)
    s_barrier
    ds_read_b64_tr_b16 v[144:145], v199 offset:0
    ds_read_b64_tr_b16 v[146:147], v199 offset:2560
    s_waitcnt lgkmcnt(10)
    v_mfma_f32_16x16x32_bf16 v[96:99], v[168:171], v[60:63], v[96:99]
    ds_read_b64_tr_b16 v[148:149], v199 offset:8
    ds_read_b64_tr_b16 v[150:151], v199 offset:2568
    s_waitcnt lgkmcnt(10)
    v_mfma_f32_16x16x32_bf16 v[100:103], v[172:175], v[60:63], v[100:103]
    ds_read_b64_tr_b16 v[152:153], v199 offset:16
    ds_read_b64_tr_b16 v[154:155], v199 offset:2576
    s_waitcnt lgkmcnt(10)
    v_mfma_f32_16x16x32_bf16 v[104:107], v[176:179], v[60:63], v[104:107]
    ds_read_b64_tr_b16 v[156:157], v199 offset:24
    ds_read_b64_tr_b16 v[158:159], v199 offset:2584
    s_waitcnt lgkmcnt(10)
    v_mfma_f32_16x16x32_bf16 v[108:111], v[180:183], v[60:63], v[108:111]
    ds_read_b64_tr_b16 v[160:161], v199 offset:32
    ds_read_b64_tr_b16 v[162:163], v199 offset:2592
    s_waitcnt lgkmcnt(10)
    v_mfma_f32_16x16x32_bf16 v[112:115], v[184:187], v[60:63], v[112:115]
    ds_read_b64_tr_b16 v[168:169], v199 offset:5120
    ds_read_b64_tr_b16 v[170:171], v199 offset:7680
    s_waitcnt lgkmcnt(10)
    v_mfma_f32_16x16x32_bf16 v[96:99], v[144:147], v[64:67], v[96:99]
    ds_read_b64_tr_b16 v[172:173], v199 offset:5128
    ds_read_b64_tr_b16 v[174:175], v199 offset:7688
    s_waitcnt lgkmcnt(10)
    v_mfma_f32_16x16x32_bf16 v[100:103], v[148:151], v[64:67], v[100:103]
    ds_read_b64_tr_b16 v[176:177], v199 offset:5136
    ds_read_b64_tr_b16 v[178:179], v199 offset:7696
    s_waitcnt lgkmcnt(10)
    v_mfma_f32_16x16x32_bf16 v[104:107], v[152:155], v[64:67], v[104:107]
    ds_read_b64_tr_b16 v[180:181], v199 offset:5144
    ds_read_b64_tr_b16 v[182:183], v199 offset:7704
    s_waitcnt lgkmcnt(10)
    v_mfma_f32_16x16x32_bf16 v[108:111], v[156:159], v[64:67], v[108:111]
    ds_read_b64_tr_b16 v[184:185], v199 offset:5152
    ds_read_b64_tr_b16 v[186:187], v199 offset:7712
    s_waitcnt lgkmcnt(10)
    v_mfma_f32_16x16x32_bf16 v[112:115], v[160:163], v[64:67], v[112:115]
    ds_read_b64_tr_b16 v[144:145], v199 offset:10240
    ds_read_b64_tr_b16 v[146:147], v199 offset:12800
    s_waitcnt lgkmcnt(10)
    v_mfma_f32_16x16x32_bf16 v[96:99], v[168:171], v[68:71], v[96:99]
    ds_read_b64_tr_b16 v[148:149], v199 offset:10248
    ds_read_b64_tr_b16 v[150:151], v199 offset:12808
    s_waitcnt lgkmcnt(10)
    v_mfma_f32_16x16x32_bf16 v[100:103], v[172:175], v[68:71], v[100:103]
    ds_read_b64_tr_b16 v[152:153], v199 offset:10256
    ds_read_b64_tr_b16 v[154:155], v199 offset:12816
    s_waitcnt lgkmcnt(10)
    v_mfma_f32_16x16x32_bf16 v[104:107], v[176:179], v[68:71], v[104:107]
    ds_read_b64_tr_b16 v[156:157], v199 offset:10264
    ds_read_b64_tr_b16 v[158:159], v199 offset:12824
    s_waitcnt lgkmcnt(10)
    v_mfma_f32_16x16x32_bf16 v[108:111], v[180:183], v[68:71], v[108:111]
    ds_read_b64_tr_b16 v[160:161], v199 offset:10272
    ds_read_b64_tr_b16 v[162:163], v199 offset:12832
    s_waitcnt lgkmcnt(10)
    v_mfma_f32_16x16x32_bf16 v[112:115], v[184:187], v[68:71], v[112:115]
    ds_read_b64_tr_b16 v[168:169], v199 offset:15360
    ds_read_b64_tr_b16 v[170:171], v199 offset:17920
    s_waitcnt lgkmcnt(10)
    v_mfma_f32_16x16x32_bf16 v[96:99], v[144:147], v[72:75], v[96:99]
    ds_read_b64_tr_b16 v[172:173], v199 offset:15368
    ds_read_b64_tr_b16 v[174:175], v199 offset:17928
    s_waitcnt lgkmcnt(10)
    v_mfma_f32_16x16x32_bf16 v[100:103], v[148:151], v[72:75], v[100:103]
    ds_read_b64_tr_b16 v[176:177], v199 offset:15376
    ds_read_b64_tr_b16 v[178:179], v199 offset:17936
    s_waitcnt lgkmcnt(10)
    v_mfma_f32_16x16x32_bf16 v[104:107], v[152:155], v[72:75], v[104:107]
    ds_read_b64_tr_b16 v[180:181], v199 offset:15384
    ds_read_b64_tr_b16 v[182:183], v199 offset:17944
    s_waitcnt lgkmcnt(10)
    v_mfma_f32_16x16x32_bf16 v[108:111], v[156:159], v[72:75], v[108:111]
    ds_read_b64_tr_b16 v[184:185], v199 offset:15392
    ds_read_b64_tr_b16 v[186:187], v199 offset:17952
    s_waitcnt lgkmcnt(10)
    v_mfma_f32_16x16x32_bf16 v[112:115], v[160:163], v[72:75], v[112:115]
    s_waitcnt vmcnt(0)
    s_barrier
    ds_read_b64_tr_b16 v[144:145], v199 offset:20480
    ds_read_b64_tr_b16 v[146:147], v199 offset:23040
    s_waitcnt lgkmcnt(10)
    v_mfma_f32_16x16x32_bf16 v[96:99], v[168:171], v[76:79], v[96:99]
    ds_read_b64_tr_b16 v[148:149], v199 offset:20488
    ds_read_b64_tr_b16 v[150:151], v199 offset:23048
    s_waitcnt lgkmcnt(10)
    v_mfma_f32_16x16x32_bf16 v[100:103], v[172:175], v[76:79], v[100:103]
    ds_read_b64_tr_b16 v[152:153], v199 offset:20496
    ds_read_b64_tr_b16 v[154:155], v199 offset:23056
    s_waitcnt lgkmcnt(10)
    v_mfma_f32_16x16x32_bf16 v[104:107], v[176:179], v[76:79], v[104:107]
    ds_read_b64_tr_b16 v[156:157], v199 offset:20504
    ds_read_b64_tr_b16 v[158:159], v199 offset:23064
    s_waitcnt lgkmcnt(10)
    v_mfma_f32_16x16x32_bf16 v[108:111], v[180:183], v[76:79], v[108:111]
    ds_read_b64_tr_b16 v[160:161], v199 offset:20512
    ds_read_b64_tr_b16 v[162:163], v199 offset:23072
    s_waitcnt lgkmcnt(10)
    v_mfma_f32_16x16x32_bf16 v[112:115], v[184:187], v[76:79], v[112:115]
    ds_read_b64_tr_b16 v[168:169], v199 offset:25600
    ds_read_b64_tr_b16 v[170:171], v199 offset:28160
    s_waitcnt lgkmcnt(10)
    v_mfma_f32_16x16x32_bf16 v[96:99], v[144:147], v[80:83], v[96:99]
    ds_read_b64_tr_b16 v[172:173], v199 offset:25608
    ds_read_b64_tr_b16 v[174:175], v199 offset:28168
    s_waitcnt lgkmcnt(10)
    v_mfma_f32_16x16x32_bf16 v[100:103], v[148:151], v[80:83], v[100:103]
    ds_read_b64_tr_b16 v[176:177], v199 offset:25616
    ds_read_b64_tr_b16 v[178:179], v199 offset:28176
    s_waitcnt lgkmcnt(10)
    v_mfma_f32_16x16x32_bf16 v[104:107], v[152:155], v[80:83], v[104:107]
    ds_read_b64_tr_b16 v[180:181], v199 offset:25624
    ds_read_b64_tr_b16 v[182:183], v199 offset:28184
    s_waitcnt lgkmcnt(10)
    v_mfma_f32_16x16x32_bf16 v[108:111], v[156:159], v[80:83], v[108:111]
    ds_read_b64_tr_b16 v[184:185], v199 offset:25632
    ds_read_b64_tr_b16 v[186:187], v199 offset:28192
    s_waitcnt lgkmcnt(10)
    v_mfma_f32_16x16x32_bf16 v[112:115], v[160:163], v[80:83], v[112:115]
    ds_read_b64_tr_b16 v[144:145], v199 offset:30720
    ds_read_b64_tr_b16 v[146:147], v199 offset:33280
    s_waitcnt lgkmcnt(10)
    v_mfma_f32_16x16x32_bf16 v[96:99], v[168:171], v[84:87], v[96:99]
    ds_read_b64_tr_b16 v[148:149], v199 offset:30728
    ds_read_b64_tr_b16 v[150:151], v199 offset:33288
    s_waitcnt lgkmcnt(10)
    v_mfma_f32_16x16x32_bf16 v[100:103], v[172:175], v[84:87], v[100:103]
    ds_read_b64_tr_b16 v[152:153], v199 offset:30736
    ds_read_b64_tr_b16 v[154:155], v199 offset:33296
    s_waitcnt lgkmcnt(10)
    v_mfma_f32_16x16x32_bf16 v[104:107], v[176:179], v[84:87], v[104:107]
    ds_read_b64_tr_b16 v[156:157], v199 offset:30744
    ds_read_b64_tr_b16 v[158:159], v199 offset:33304
    s_waitcnt lgkmcnt(10)
    v_mfma_f32_16x16x32_bf16 v[108:111], v[180:183], v[84:87], v[108:111]
    ds_read_b64_tr_b16 v[160:161], v199 offset:30752
    ds_read_b64_tr_b16 v[162:163], v199 offset:33312
    s_waitcnt lgkmcnt(10)
    v_mfma_f32_16x16x32_bf16 v[112:115], v[184:187], v[84:87], v[112:115]
    ds_read_b64_tr_b16 v[168:169], v199 offset:35840
    ds_read_b64_tr_b16 v[170:171], v199 offset:38400
    s_waitcnt lgkmcnt(10)
    v_mfma_f32_16x16x32_bf16 v[96:99], v[144:147], v[88:91], v[96:99]
    ds_read_b64_tr_b16 v[172:173], v199 offset:35848
    ds_read_b64_tr_b16 v[174:175], v199 offset:38408
    s_waitcnt lgkmcnt(10)
    v_mfma_f32_16x16x32_bf16 v[100:103], v[148:151], v[88:91], v[100:103]
    ds_read_b64_tr_b16 v[176:177], v199 offset:35856
    ds_read_b64_tr_b16 v[178:179], v199 offset:38416
    s_waitcnt lgkmcnt(10)
    v_mfma_f32_16x16x32_bf16 v[104:107], v[152:155], v[88:91], v[104:107]
    ds_read_b64_tr_b16 v[180:181], v199 offset:35864
    ds_read_b64_tr_b16 v[182:183], v199 offset:38424
    s_waitcnt lgkmcnt(10)
    v_mfma_f32_16x16x32_bf16 v[108:111], v[156:159], v[88:91], v[108:111]
    ds_read_b64_tr_b16 v[184:185], v199 offset:35872
    ds_read_b64_tr_b16 v[186:187], v199 offset:38432
    s_waitcnt lgkmcnt(10)
    v_mfma_f32_16x16x32_bf16 v[112:115], v[160:163], v[88:91], v[112:115]
    s_waitcnt lgkmcnt(8)
    v_mfma_f32_16x16x32_bf16 v[96:99], v[168:171], v[92:95], v[96:99]
    s_waitcnt lgkmcnt(6)
    v_mfma_f32_16x16x32_bf16 v[100:103], v[172:175], v[92:95], v[100:103]
    s_waitcnt lgkmcnt(4)
    v_mfma_f32_16x16x32_bf16 v[104:107], v[176:179], v[92:95], v[104:107]
    s_waitcnt lgkmcnt(2)
    v_mfma_f32_16x16x32_bf16 v[108:111], v[180:183], v[92:95], v[108:111]
    s_waitcnt lgkmcnt(0)
    v_mfma_f32_16x16x32_bf16 v[112:115], v[184:187], v[92:95], v[112:115]
    s_mov_b32 s56, s36
    s_and_b32 s57, s37, 0xffff
    s_mov_b32 s58, 2621440
    s_mov_b32 s59, 0x00020000
    s_nop 3
    v_cvt_pk_bf16_f32 v96, v96, v97
    v_cvt_pk_bf16_f32 v97, v98, v99
    ds_write_b64 v13, v[96:97] offset:0
    v_cvt_pk_bf16_f32 v100, v100, v101
    v_cvt_pk_bf16_f32 v101, v102, v103
    ds_write_b64 v13, v[100:101] offset:8
    v_cvt_pk_bf16_f32 v104, v104, v105
    v_cvt_pk_bf16_f32 v105, v106, v107
    ds_write_b64 v13, v[104:105] offset:16
    v_cvt_pk_bf16_f32 v108, v108, v109
    v_cvt_pk_bf16_f32 v109, v110, v111
    ds_write_b64 v13, v[108:109] offset:24
    v_cvt_pk_bf16_f32 v112, v112, v113
    v_cvt_pk_bf16_f32 v113, v114, v115
    ds_write_b64 v13, v[112:113] offset:32
    s_waitcnt lgkmcnt(0)
    ds_read_b128 v[228:231], v14 offset:0
    ds_read_b128 v[232:235], v14 offset:1024
    ds_read_b128 v[236:239], v14 offset:2048
    s_waitcnt lgkmcnt(2)
    v_lshlrev_b32 v2, 16, v228
    v_and_b32 v3, v12, v228
    v_pk_mul_f32 v[2:3], v[2:3], v[204:205]
    v_cvt_pk_bf16_f32 v3, v2, v3
    v_lshlrev_b32 v2, 16, v3
    v_and_b32 v3, v12, v3
    v_pk_add_f32 v[2:3], v[2:3], v[120:121]
    v_cvt_pk_bf16_f32 v228, v2, v3
    v_lshlrev_b32 v6, 16, v229
    v_and_b32 v7, v12, v229
    v_pk_mul_f32 v[6:7], v[6:7], v[206:207]
    v_cvt_pk_bf16_f32 v7, v6, v7
    v_lshlrev_b32 v6, 16, v7
    v_and_b32 v7, v12, v7
    v_pk_add_f32 v[6:7], v[6:7], v[122:123]
    v_cvt_pk_bf16_f32 v229, v6, v7
    v_lshlrev_b32 v2, 16, v230
    v_and_b32 v3, v12, v230
    v_pk_mul_f32 v[2:3], v[2:3], v[208:209]
    v_cvt_pk_bf16_f32 v3, v2, v3
    v_lshlrev_b32 v2, 16, v3
    v_and_b32 v3, v12, v3
    v_pk_add_f32 v[2:3], v[2:3], v[124:125]
    v_cvt_pk_bf16_f32 v230, v2, v3
    v_lshlrev_b32 v6, 16, v231
    v_and_b32 v7, v12, v231
    v_pk_mul_f32 v[6:7], v[6:7], v[210:211]
    v_cvt_pk_bf16_f32 v7, v6, v7
    v_lshlrev_b32 v6, 16, v7
    v_and_b32 v7, v12, v7
    v_pk_add_f32 v[6:7], v[6:7], v[126:127]
    v_cvt_pk_bf16_f32 v231, v6, v7
    buffer_store_dwordx4 v[228:231], v246, s[56:59], s10 offen
    s_waitcnt lgkmcnt(1)
    v_lshlrev_b32 v2, 16, v232
    v_and_b32 v3, v12, v232
    v_pk_mul_f32 v[2:3], v[2:3], v[212:213]
    v_cvt_pk_bf16_f32 v3, v2, v3
    v_lshlrev_b32 v2, 16, v3
    v_and_b32 v3, v12, v3
    v_pk_add_f32 v[2:3], v[2:3], v[128:129]
    v_cvt_pk_bf16_f32 v232, v2, v3
    v_lshlrev_b32 v6, 16, v233
    v_and_b32 v7, v12, v233
    v_pk_mul_f32 v[6:7], v[6:7], v[214:215]
    v_cvt_pk_bf16_f32 v7, v6, v7
    v_lshlrev_b32 v6, 16, v7
    v_and_b32 v7, v12, v7
    v_pk_add_f32 v[6:7], v[6:7], v[130:131]
    v_cvt_pk_bf16_f32 v233, v6, v7
    v_lshlrev_b32 v2, 16, v234
    v_and_b32 v3, v12, v234
    v_pk_mul_f32 v[2:3], v[2:3], v[216:217]
    v_cvt_pk_bf16_f32 v3, v2, v3
    v_lshlrev_b32 v2, 16, v3
    v_and_b32 v3, v12, v3
    v_pk_add_f32 v[2:3], v[2:3], v[132:133]
    v_cvt_pk_bf16_f32 v234, v2, v3
    v_lshlrev_b32 v6, 16, v235
    v_and_b32 v7, v12, v235
    v_pk_mul_f32 v[6:7], v[6:7], v[218:219]
    v_cvt_pk_bf16_f32 v7, v6, v7
    v_lshlrev_b32 v6, 16, v7
    v_and_b32 v7, v12, v7
    v_pk_add_f32 v[6:7], v[6:7], v[134:135]
    v_cvt_pk_bf16_f32 v235, v6, v7
    buffer_store_dwordx4 v[232:235], v247, s[56:59], s10 offen
    s_waitcnt lgkmcnt(0)
    v_lshlrev_b32 v2, 16, v236
    v_and_b32 v3, v12, v236
    v_pk_mul_f32 v[2:3], v[2:3], v[220:221]
    v_cvt_pk_bf16_f32 v3, v2, v3
    v_lshlrev_b32 v2, 16, v3
    v_and_b32 v3, v12, v3
    v_pk_add_f32 v[2:3], v[2:3], v[136:137]
    v_cvt_pk_bf16_f32 v236, v2, v3
    v_lshlrev_b32 v6, 16, v237
    v_and_b32 v7, v12, v237
    v_pk_mul_f32 v[6:7], v[6:7], v[222:223]
    v_cvt_pk_bf16_f32 v7, v6, v7
    v_lshlrev_b32 v6, 16, v7
    v_and_b32 v7, v12, v7
    v_pk_add_f32 v[6:7], v[6:7], v[138:139]
    v_cvt_pk_bf16_f32 v237, v6, v7
    v_lshlrev_b32 v2, 16, v238
    v_and_b32 v3, v12, v238
    v_pk_mul_f32 v[2:3], v[2:3], v[224:225]
    v_cvt_pk_bf16_f32 v3, v2, v3
    v_lshlrev_b32 v2, 16, v3
    v_and_b32 v3, v12, v3
    v_pk_add_f32 v[2:3], v[2:3], v[140:141]
    v_cvt_pk_bf16_f32 v238, v2, v3
    v_lshlrev_b32 v6, 16, v239
    v_and_b32 v7, v12, v239
    v_pk_mul_f32 v[6:7], v[6:7], v[226:227]
    v_cvt_pk_bf16_f32 v7, v6, v7
    v_lshlrev_b32 v6, 16, v7
    v_and_b32 v7, v12, v7
    v_pk_add_f32 v[6:7], v[6:7], v[142:143]
    v_cvt_pk_bf16_f32 v239, v6, v7
    s_mov_b32 exec_hi, 0
    buffer_store_dwordx4 v[236:239], v248, s[56:59], s10 offen
    s_mov_b32 exec_hi, -1
l3_kernel_end:
    s_endpgm
.section .rodata,"a"
.p2align 6
.amdhsa_kernel l1_kernel
  .amdhsa_next_free_vgpr 232
  .amdhsa_next_free_sgpr 96
  .amdhsa_accum_offset 232
  .amdhsa_group_segment_fixed_size 0
  .amdhsa_kernarg_size 104
  .amdhsa_user_sgpr_count 2
  .amdhsa_user_sgpr_kernarg_segment_ptr 1
  .amdhsa_system_sgpr_workgroup_id_x 1
.end_amdhsa_kernel
.p2align 6
.amdhsa_kernel l2_kernel
  .amdhsa_next_free_vgpr 168
  .amdhsa_next_free_sgpr 96
  .amdhsa_accum_offset 168
  .amdhsa_group_segment_fixed_size 0
  .amdhsa_kernarg_size 104
  .amdhsa_user_sgpr_count 2
  .amdhsa_user_sgpr_kernarg_segment_ptr 1
  .amdhsa_system_sgpr_workgroup_id_x 1
.end_amdhsa_kernel
.p2align 6
.amdhsa_kernel l3_kernel
  .amdhsa_next_free_vgpr 252
  .amdhsa_next_free_sgpr 102
  .amdhsa_accum_offset 252
  .amdhsa_group_segment_fixed_size 0
  .amdhsa_kernarg_size 104
  .amdhsa_user_sgpr_count 2
  .amdhsa_user_sgpr_kernarg_segment_ptr 1
  .amdhsa_system_sgpr_workgroup_id_x 1
.end_amdhsa_kernel
```
